```python
import torch

def _softmax(x, axis=-1):
    return torch.softmax(x, dim=axis)
def _gelu(x):
    return torch.nn.functional.gelu(x, approximate="tanh")
def _silu(x):
    return torch.nn.functional.silu(x)
def _sigmoid(x):
    return torch.sigmoid(x)
def _layernorm(x, axis=-1, eps=1e-5):
    m = x.mean(dim=axis, keepdim=True)
    v = x.var(dim=axis, keepdim=True, unbiased=False)
    return (x - m) / torch.sqrt(v + eps)
def _scatter_add(tgt, idx, src, axis=0):
    return tgt.clone().index_add_(axis, idx, src)
def _segment_sum(src, seg, n):
    out = torch.zeros((n,) + src.shape[1:], dtype=src.dtype)
    return out.index_add_(0, seg, src)
def _pad(x, pw):
    flat = tuple(v for pair in reversed(pw) for v in pair)
    return torch.nn.functional.pad(x, flat)

kernel_name = 'standalone__glu_gated_geglu__prompt'

def setup_inputs():

    _w = (lambda a: (lambda t: t.to(torch.bfloat16) if t.is_floating_point() else t)(torch.as_tensor(a)))
    B, S, Dm, Df = 1, 2048, 640, 1536
    return {
        "x": _w((lambda *s: torch.randn(*s, dtype=torch.bfloat16) * 0.05)(B, S, Dm)),
        "w_gate": _w((lambda *s: torch.randn(*s, dtype=torch.bfloat16) * 0.05)(Dm, Df) * (Dm ** -0.5)),
        "w_up": _w((lambda *s: torch.randn(*s, dtype=torch.bfloat16) * 0.05)(Dm, Df) * (Dm ** -0.5)),
        "w_down": _w((lambda *s: torch.randn(*s, dtype=torch.bfloat16) * 0.05)(Df, Dm) * (Df ** -0.5)),
    }

def reference(x, w_gate, w_up, w_down):
    g = torch.einsum("bsd,df->bsf", x, w_gate)
    u = torch.einsum("bsd,df->bsf", x, w_up)
    h = _gelu(g) * u
    return torch.einsum("bsf,fd->bsd", h, w_down)
```

```asm
; @launch grid=(256,1,1) block=(256,1,1) lds=163840
.amdgcn_target "amdgcn-amd-amdhsa--gfx950"
.text
.p2align 12
.fill 0, 4, 0xbf800000
.globl standalone__glu_gated_geglu__prompt_kernel
.p2align 8
.type standalone__glu_gated_geglu__prompt_kernel,@function
standalone__glu_gated_geglu__prompt_kernel:
    s_cmp_ge_u32 s2, 256
    s_cbranch_scc1 L_end
    s_load_dwordx2 s[8:9], s[0:1], 0
    s_load_dwordx2 s[12:13], s[0:1], 8
    s_load_dwordx2 s[16:17], s[0:1], 16
    s_load_dwordx2 s[20:21], s[0:1], 24
    s_load_dwordx2 s[24:25], s[0:1], 48
    s_load_dwordx2 s[32:33], s[0:1], 40
    s_load_dwordx2 s[28:29], s[0:1], 32
    v_lshrrev_b32 v107, 6, v0
    v_and_b32 v1, 63, v0
    v_readfirstlane_b32 s36, v107
    s_mov_b32 s10, 2621440
    s_mov_b32 s11, 0x20000
    s_mov_b32 s14, 1966080
    s_mov_b32 s15, 0x20000
    s_mov_b32 s18, 1966080
    s_mov_b32 s19, 0x20000
    s_and_b32 s39, s2, 7
    s_lshr_b32 s54, s2, 3
    s_cmp_ge_u32 s54, 30
    s_cbranch_scc1 L_wide
    v_lshrrev_b32 v108, 3, v1
    v_mad_u32_u24 v108, v107, 48, v108
    v_mul_u32_u24 v108, 1280, v108
    v_lshrrev_b32 v109, 4, v1
    v_and_b32 v110, 7, v1
    v_xor_b32 v31, v110, v109
    v_lshl_add_u32 v2, v31, 4, v108
    v_xor_b32 v31, 4, v31
    v_lshl_add_u32 v3, v31, 4, v108
    v_add_u32 v4, 18432, v2
    v_add_u32 v3, 9216, v3
    v_add_u32 v5, 18432, v3
    s_mul_i32 s60, s54, 43
    s_lshr_b32 s60, s60, 8
    s_mul_i32 s5, s60, 6
    s_sub_u32 s5, s54, s5
    s_lshr_b32 s37, s39, 2
    s_mul_i32 s37, s37, 5
    s_add_u32 s37, s37, s60
    s_and_b32 s4, s39, 3
    s_mul_i32 s38, s4, 6
    s_add_u32 s38, s38, s5
    s_mul_i32 s50, s37, 245760
    s_mul_i32 s43, s36, 6144
    s_lshl_b32 s51, s38, 7
    s_add_u32 s3, s43, 4096
    s_lshl_b32 s44, s36, 11
    s_add_u32 s45, s44, 32768
    s_add_u32 s44, s44, 24576
    v_lshrrev_b32 v108, 3, v1
    v_lshl_add_u32 v108, v107, 4, v108
    v_mul_u32_u24 v108, 3072, v108
    v_and_b32 v109, 1, v109
    v_lshlrev_b32 v109, 1, v109
    v_xor_b32 v109, v110, v109
    v_lshl_add_u32 v6, v109, 4, v108
    v_xor_b32 v109, 4, v109
    v_lshl_add_u32 v7, v109, 4, v108
    v_add_u32 v7, 23552, v7
    s_lshr_b32 s58, s4, 1
    s_add_u32 s58, s58, s4
    s_lshr_b32 s59, s39, 2
    s_lshl_b32 s59, s59, 1
    s_add_u32 s58, s58, s59
    s_add_u32 s59, s60, s5
    s_and_b32 s59, s59, 1
    s_mul_i32 s59, s59, 5
    s_add_u32 s58, s58, s59
    s_sub_u32 s59, s58, 10
    s_cmp_ge_u32 s58, 10
    s_cselect_b32 s58, s59, s58
    s_lshl_b32 s40, s58, 7
    s_add_u32 s40, s40, s50
    s_mul_i32 s41, s58, 196608
    s_add_u32 s41, s41, s51
    s_add_u32 s55, s50, 1280
    s_mov_b32 s42, 0
    s_add_u32 s57, s40, 40960
    s_waitcnt lgkmcnt(0)
    s_add_u32 m0, s42, s43
    s_nop 0
    buffer_load_dwordx4 v2, s[8:11], s40 offen offset:0 lds
    buffer_load_dwordx4 v3, s[8:11], s40 offen offset:1024 lds
    buffer_load_dwordx4 v4, s[8:11], s40 offen offset:2048 lds
    buffer_load_dwordx4 v5, s[8:11], s40 offen offset:3072 lds
    s_add_u32 m0, s42, s3
    s_nop 0
    buffer_load_dwordx4 v2, s[8:11], s57 offen offset:0 lds
    buffer_load_dwordx4 v3, s[8:11], s57 offen offset:1024 lds
    s_add_u32 m0, s42, s44
    s_nop 0
    buffer_load_dwordx4 v6, s[12:15], s41 offen offset:0 lds
    buffer_load_dwordx4 v7, s[12:15], s41 offen offset:1024 lds
    s_add_u32 m0, s42, s45
    s_nop 0
    buffer_load_dwordx4 v6, s[16:19], s41 offen offset:0 lds
    buffer_load_dwordx4 v7, s[16:19], s41 offen offset:1024 lds
    s_add_u32 s40, s40, 128
    s_add_u32 s41, s41, 196608
    s_cmp_eq_u32 s40, s55
    s_cselect_b32 s40, s50, s40
    s_cselect_b32 s41, s51, s41
    s_add_u32 s42, s42, 40960
    s_cmp_eq_u32 s42, 122880
    s_cselect_b32 s42, 0, s42
    s_add_u32 s57, s40, 40960
    s_mov_b32 s34, 256
    s_mov_b32 s35, 0x20000
    v_mov_b32 v30, 0
    v_mov_b32 v119, 0x40000000
    s_lshl_b32 s60, s2, 2
    s_add_u32 s60, s60, s36
    s_cmp_lg_u32 s60, 3
    s_cbranch_scc1 L_notag
    s_memrealtime s[60:61]
    s_waitcnt lgkmcnt(0)
    s_or_b32 s61, s61, 0x80000000
    v_mov_b32 v120, s60
    v_mov_b32 v121, s61
    v_mov_b32 v119, 0
    buffer_store_dwordx2 v[120:121], v30, s[32:35], 0 offen sc1
L_notag:
    s_mul_i32 s60, s54, 52
    s_lshr_b32 s60, s60, 8
    s_mul_i32 s101, s60, 5
    s_sub_u32 s101, s54, s101
    s_lshr_b32 s59, s39, 1
    s_mul_i32 s59, s59, 6
    s_add_u32 s59, s59, s60
    s_and_b32 s60, s39, 1
    s_mul_i32 s60, s60, 5
    s_add_u32 s101, s101, s60
    s_getpc_b64 s[66:67]
LT_tp:
    s_lshl_b32 s60, s59, 6
    s_add_u32 s60, s60, L_table-LT_tp
    s_add_u32 s66, s66, s60
    s_addc_u32 s67, s67, 0
    s_load_dwordx16 s[68:83], s[66:67], 0
    s_mov_b64 exec, 0
    s_cmp_eq_u32 s36, 0
    s_cbranch_scc1 LT_hop0
    s_cmp_eq_u32 s36, 1
    s_cbranch_scc1 LT_hop1
    s_cmp_eq_u32 s36, 2
    s_cbranch_scc1 LT_hop2
    s_branch LT_hopA
LT_back:
    s_mov_b64 exec, -1
    s_add_u32 m0, s42, s43
    s_nop 0
    buffer_load_dwordx4 v2, s[8:11], s40 offen offset:0 lds
    s_mov_b32 s46, 0
    s_mov_b32 s49, 40960
    s_mov_b32 s100, 196608
    s_mov_b32 s98, 0xffe50000
    s_lshr_b32 s63, s36, 1
    s_and_b32 s64, s36, 1
    v_and_b32 v107, 15, v1
    v_lshrrev_b32 v108, 4, v1
    buffer_load_dwordx4 v3, s[8:11], s40 offen offset:1024 lds
    v_bfe_u32 v109, v1, 1, 3
    v_xor_b32 v109, v109, v108
    s_mul_i32 s65, s63, 12288
    v_lshlrev_b32 v110, 7, v107
    v_add_u32 v110, s65, v110
    v_lshl_add_u32 v12, v109, 4, v110
    v_xor_b32 v31, 4, v109
    v_lshl_add_u32 v13, v31, 4, v110
    buffer_load_dwordx4 v4, s[8:11], s40 offen offset:2048 lds
    v_bfe_u32 v110, v1, 4, 1
    v_bfe_u32 v109, v1, 2, 2
    v_lshl_add_u32 v31, v108, 3, v109
    v_mul_u32_u24 v31, 128, v31
    v_and_b32 v111, 3, v1
    v_lshl_add_u32 v31, v111, 3, v31
    s_lshl_b32 s65, s64, 1
    v_bfe_u32 v107, v1, 3, 2
    buffer_load_dwordx4 v5, s[8:11], s40 offen offset:3072 lds
    v_xor_b32 v107, s65, v107
    v_lshl_add_u32 v16, v107, 5, v31
    v_xor_b32 v107, 1, v107
    v_lshl_add_u32 v17, v107, 5, v31
    s_mul_i32 s88, s2, 10240
    s_add_u32 s88, s88, 384
    s_lshr_b32 s60, s39, 2
    s_lshl_b32 s60, s60, 5
    s_add_u32 m0, s42, s3
    s_nop 0
    buffer_load_dwordx4 v2, s[8:11], s57 offen offset:0 lds
    s_add_u32 s60, s60, s54
    s_mul_i32 s60, s60, 3072
    s_mul_i32 s61, s4, 768
    s_add_u32 s60, s60, s61
    s_add_u32 s60, s60, 589824
    s_lshr_b32 s61, s39, 1
    s_lshl_b32 s61, s61, 5
    s_add_u32 s61, s61, s54
    buffer_load_dwordx4 v3, s[8:11], s57 offen offset:1024 lds
    s_mul_i32 s61, s61, 15360
    s_and_b32 s62, s39, 1
    s_mul_i32 s62, s62, 640
    s_add_u32 s61, s61, s62
    s_mov_b32 s89, 196608
    s_mov_b32 s62, 5
    s_mov_b32 s90, 128
    s_mov_b32 s91, 0
    s_add_u32 m0, s42, s44
    s_nop 0
    buffer_load_dwordx4 v6, s[12:15], s41 offen offset:0 lds
    s_cmp_eq_u32 s36, 3
    s_cselect_b32 s60, s61, s60
    s_cselect_b32 s89, 2560, s89
    s_cselect_b32 s62, 9, s62
    s_cselect_b32 s91, 640, s91
    s_cselect_b64 s[92:93], s[20:21], s[12:13]
    s_cmp_eq_u32 s36, 2
    s_cselect_b64 s[92:93], s[16:17], s[92:93]
    buffer_load_dwordx4 v7, s[12:15], s41 offen offset:1024 lds
    s_cmp_eq_u32 s36, 0
    s_cselect_b32 s88, s88, s60
    s_cselect_b32 s89, 128, s89
    s_cselect_b32 s62, 7, s62
    s_cselect_b32 s90, 1280, s90
    s_cselect_b64 s[92:93], s[8:9], s[92:93]
    s_cselect_b32 s94, s10, s14
    s_mov_b32 s95, 0x20000
    s_add_u32 m0, s42, s45
    s_nop 0
    buffer_load_dwordx4 v6, s[16:19], s41 offen offset:0 lds
    v_min_u32 v90, s62, v1
    v_mul_u32_u24 v91, 13108, v90
    v_lshrrev_b32 v91, 16, v91
    v_mul_u32_u24 v91, s91, v91
    v_mad_u32_u24 v90, v90, s90, v91
    s_mul_i32 s90, s89, 7
    s_cmp_eq_u32 s36, 3
    s_cselect_b32 s90, 15360, s90
    buffer_load_dwordx4 v7, s[16:19], s41 offen offset:1024 lds
    s_add_u32 s90, s90, s88
    s_cmp_eq_u32 s36, 3
    s_cselect_b32 s88, s88, 0x40000000
    s_add_u32 s40, s40, 128
    s_add_u32 s41, s41, 196608
    s_cmp_eq_u32 s40, s55
    s_cselect_b32 s40, s50, s40
    s_cselect_b32 s41, s51, s41
    s_add_u32 s42, s42, 40960
    s_cmp_eq_u32 s42, 122880
    s_cselect_b32 s42, 0, s42
    s_add_u32 s57, s40, 40960
    s_waitcnt vmcnt(10) lgkmcnt(0)
    s_barrier
    ds_read_b128 v[64:67], v12 offset:0
    ds_read_b64_tr_b16 v[32:33], v16 offset:24576
    ds_read_b128 v[68:71], v12 offset:2048
    s_add_u32 s46, s46, 40960
    s_cmp_eq_u32 s46, 122880
    s_cselect_b32 s47, 0xfffec000, s49
    s_cselect_b32 s46, 0, s46
    ds_read_b64_tr_b16 v[34:35], v16 offset:25088
    ds_read_b64_tr_b16 v[36:37], v16 offset:32768
    ds_read_b64_tr_b16 v[38:39], v16 offset:33280
    ds_read_b128 v[72:75], v12 offset:4096
    ds_read_b64_tr_b16 v[40:41], v17 offset:24576
    ds_read_b64_tr_b16 v[42:43], v17 offset:25088
    ds_read_b64_tr_b16 v[44:45], v17 offset:32768
    ds_read_b128 v[76:79], v12 offset:6144
    ds_read_b64_tr_b16 v[46:47], v17 offset:33280
    buffer_load_dwordx2 v[24:25], v30, s[32:35], 0 offen sc1
    ds_read_b128 v[80:83], v12 offset:8192
    s_add_u32 m0, s42, s43
    s_nop 0
    buffer_load_dwordx4 v2, s[8:11], s40 offen offset:0 lds
    buffer_load_dwordx4 v3, s[8:11], s40 offen offset:1024 lds
    buffer_load_dwordx4 v4, s[8:11], s40 offen offset:2048 lds
    ds_read_b128 v[84:87], v12 offset:10240
    s_waitcnt lgkmcnt(2)
    v_mfma_f32_16x16x32_bf16 v[160:163], v[32:35], v[64:67], 0
    ds_read_b64_tr_b16 v[48:49], v16 offset:28672
    v_add_u32 v12, s47, v12
    s_mov_b32 s22, 1966080
    v_mfma_f32_16x16x32_bf16 v[168:171], v[36:39], v[64:67], 0
    ds_read_b64_tr_b16 v[50:51], v16 offset:29184
    s_mov_b32 s23, 0x20000
    s_mov_b32 s26, 9437184
    v_mfma_f32_16x16x32_bf16 v[176:179], v[40:43], v[64:67], 0
    ds_read_b64_tr_b16 v[52:53], v16 offset:36864
    s_mov_b32 s27, 0x20000
    s_mov_b32 s30, 2621440
    v_mfma_f32_16x16x32_bf16 v[184:187], v[44:47], v[64:67], 0
    ds_read_b128 v[64:67], v13 offset:0
    s_mov_b32 s31, 0x20000
    s_mul_i32 s7, s36, 10240
    v_mfma_f32_16x16x32_bf16 v[188:191], v[44:47], v[68:71], 0
    ds_read_b64_tr_b16 v[54:55], v16 offset:37376
    s_and_b32 s60, s59, 1
    s_mul_i32 s60, s60, 6
    v_mfma_f32_16x16x32_bf16 v[180:183], v[40:43], v[68:71], 0
    ds_read_b64_tr_b16 v[56:57], v17 offset:28672
    v_add_u32 v16, s47, v16
    s_mul_i32 s61, s36, 12
    v_mfma_f32_16x16x32_bf16 v[172:175], v[36:39], v[68:71], 0
    ds_read_b64_tr_b16 v[58:59], v17 offset:29184
    s_add_u32 s53, s61, s60
    s_xor_b32 s60, s60, 6
    v_mfma_f32_16x16x32_bf16 v[164:167], v[32:35], v[68:71], 0
    ds_read_b128 v[68:71], v13 offset:2048
    s_add_u32 s96, s61, s60
    s_mul_i32 s56, s53, 40960
    v_mfma_f32_16x16x32_bf16 v[192:195], v[32:35], v[72:75], 0
    ds_read_b64_tr_b16 v[60:61], v17 offset:36864
    s_mul_i32 s6, s96, 40960
    s_lshl_b32 s53, s53, 10
    v_mfma_f32_16x16x32_bf16 v[200:203], v[36:39], v[72:75], 0
    ds_read_b64_tr_b16 v[62:63], v17 offset:37376
    s_lshl_b32 s96, s96, 10
    s_lshl_b32 s60, s101, 7
    v_mfma_f32_16x16x32_bf16 v[208:211], v[40:43], v[72:75], 0
    buffer_load_dwordx4 v5, s[8:11], s40 offen offset:3072 lds
    v_add_u32 v17, s47, v17
    v_mfma_f32_16x16x32_bf16 v[216:219], v[44:47], v[72:75], 0
    ds_read_b128 v[72:75], v13 offset:4096
    s_add_u32 m0, s42, s3
    s_waitcnt lgkmcnt(12)
    v_mfma_f32_16x16x32_bf16 v[220:223], v[44:47], v[76:79], 0
    buffer_load_dwordx4 v2, s[8:11], s57 offen offset:0 lds
    s_cmp_eq_u32 s59, 25
    s_cselect_b32 s60, 0x40000000, s60
    v_mfma_f32_16x16x32_bf16 v[212:215], v[40:43], v[76:79], 0
    buffer_load_dwordx4 v3, s[8:11], s57 offen offset:1024 lds
    s_add_u32 s56, s56, s60
    s_add_u32 s6, s6, s60
    v_mfma_f32_16x16x32_bf16 v[204:207], v[36:39], v[76:79], 0
    s_add_u32 s40, s40, 128
    v_lshlrev_b32 v130, 4, v1
    v_lshrrev_b32 v107, 3, v1
    v_mfma_f32_16x16x32_bf16 v[196:199], v[32:35], v[76:79], 0
    ds_read_b128 v[76:79], v13 offset:6144
    s_add_u32 m0, s42, s44
    v_mul_u32_u24 v107, 1280, v107
    v_mfma_f32_16x16x32_bf16 v[224:227], v[32:35], v[80:83], 0
    buffer_load_dwordx4 v6, s[12:15], s41 offen offset:0 lds
    v_lshlrev_b32 v108, 1, v108
    v_mfma_f32_16x16x32_bf16 v[232:235], v[36:39], v[80:83], 0
    buffer_load_dwordx4 v7, s[12:15], s41 offen offset:1024 lds
    v_and_b32 v31, 7, v1
    v_mfma_f32_16x16x32_bf16 v[240:243], v[40:43], v[80:83], 0
    s_cmp_eq_u32 s40, s55
    s_cselect_b32 s40, s50, s40
    s_cselect_b32 s99, s98, s100
    v_mfma_f32_16x16x32_bf16 v[248:251], v[44:47], v[80:83], 0
    ds_read_b128 v[80:83], v13 offset:8192
    s_add_u32 m0, s42, s45
    s_waitcnt lgkmcnt(13)
    v_mfma_f32_16x16x32_bf16 v[252:255], v[44:47], v[84:87], 0
    buffer_load_dwordx4 v6, s[16:19], s41 offen offset:0 lds
    s_add_u32 s57, s40, 40960
    v_xor_b32 v31, v31, v108
    v_mfma_f32_16x16x32_bf16 v[244:247], v[40:43], v[84:87], 0
    buffer_load_dwordx4 v7, s[16:19], s41 offen offset:1024 lds
    v_lshl_add_u32 v9, v31, 4, v107
    v_mfma_f32_16x16x32_bf16 v[236:239], v[36:39], v[84:87], 0
    s_add_u32 s41, s41, s99
    v_add_u32 v10, 9216, v9
    v_add_u32 v11, 18432, v9
    v_mfma_f32_16x16x32_bf16 v[228:231], v[32:35], v[84:87], 0
    ds_read_b128 v[84:87], v13 offset:10240
    v_add_u32 v14, 27648, v9
    s_waitcnt lgkmcnt(3)
    v_mfma_f32_16x16x32_bf16 v[160:163], v[48:51], v[64:67], v[160:163]
    v_add_u32 v13, s47, v13
    v_lshrrev_b32 v107, 5, v1
    v_mfma_f32_16x16x32_bf16 v[168:171], v[52:55], v[64:67], v[168:171]
    s_add_u32 s42, s42, 40960
    s_cmp_eq_u32 s42, 122880
    s_cselect_b32 s42, 0, s42
    v_mfma_f32_16x16x32_bf16 v[176:179], v[56:59], v[64:67], v[176:179]
    v_lshlrev_b32 v107, 4, v107
    v_lshl_add_u32 v107, v110, 2, v107
    v_mfma_f32_16x16x32_bf16 v[184:187], v[60:63], v[64:67], v[184:187]
    v_add_u32 v107, v107, v109
    v_lshlrev_b32 v107, 7, v107
    v_mfma_f32_16x16x32_bf16 v[188:191], v[60:63], v[68:71], v[188:191]
    v_lshl_add_u32 v107, v111, 3, v107
    v_add_u32 v107, s7, v107
    v_bfe_u32 v31, v1, 3, 2
    v_lshl_add_u32 v100, v31, 5, v107
    v_add_u32 v99, 0x10000, v100
    v_xor_b32 v108, 1, v31
    v_lshl_add_u32 v101, v108, 5, v107
    v_add_u32 v104, 0x10000, v101
    v_xor_b32 v108, 2, v31
    v_lshl_add_u32 v102, v108, 5, v107
    v_add_u32 v105, 0x10000, v102
    v_xor_b32 v108, 3, v31
    v_lshl_add_u32 v103, v108, 5, v107
    v_add_u32 v106, 0x10000, v103
    buffer_load_dword v91, v90, s[92:95], s88 offen
    s_add_u32 s88, s88, s89
    s_waitcnt vmcnt(12) lgkmcnt(0)
    s_barrier
    s_mov_b32 s48, 7
LT_loop:
    v_mfma_f32_16x16x32_bf16 v[180:183], v[56:59], v[68:71], v[180:183]
    ds_read_b128 v[64:67], v12 offset:0
    v_mfma_f32_16x16x32_bf16 v[172:175], v[52:55], v[68:71], v[172:175]
    ds_read_b64_tr_b16 v[32:33], v16 offset:24576
    v_mfma_f32_16x16x32_bf16 v[164:167], v[48:51], v[68:71], v[164:167]
    ds_read_b128 v[68:71], v12 offset:2048
    s_add_u32 m0, s42, s43
    v_mfma_f32_16x16x32_bf16 v[192:195], v[48:51], v[72:75], v[192:195]
    buffer_load_dwordx4 v2, s[8:11], s40 offen offset:0 lds
    s_add_u32 s46, s46, 40960
    s_cmp_eq_u32 s46, 122880
    v_mfma_f32_16x16x32_bf16 v[200:203], v[52:55], v[72:75], v[200:203]
    s_cselect_b32 s47, 0xfffec000, s49
    s_cselect_b32 s46, 0, s46
    ds_read_b64_tr_b16 v[34:35], v16 offset:25088
    v_mfma_f32_16x16x32_bf16 v[208:211], v[56:59], v[72:75], v[208:211]
    ds_read_b64_tr_b16 v[36:37], v16 offset:32768
    s_sub_u32 s48, s48, 1
    v_mfma_f32_16x16x32_bf16 v[216:219], v[60:63], v[72:75], v[216:219]
    ds_read_b128 v[72:75], v12 offset:4096
    v_mfma_f32_16x16x32_bf16 v[220:223], v[60:63], v[76:79], v[220:223]
    ds_read_b64_tr_b16 v[38:39], v16 offset:33280
    v_mfma_f32_16x16x32_bf16 v[212:215], v[56:59], v[76:79], v[212:215]
    buffer_load_dwordx4 v3, s[8:11], s40 offen offset:1024 lds
    v_mfma_f32_16x16x32_bf16 v[204:207], v[52:55], v[76:79], v[204:207]
    ds_read_b64_tr_b16 v[40:41], v17 offset:24576
    v_mfma_f32_16x16x32_bf16 v[196:199], v[48:51], v[76:79], v[196:199]
    ds_read_b128 v[76:79], v12 offset:6144
    v_mfma_f32_16x16x32_bf16 v[224:227], v[48:51], v[80:83], v[224:227]
    ds_read_b64_tr_b16 v[42:43], v17 offset:25088
    v_mfma_f32_16x16x32_bf16 v[232:235], v[52:55], v[80:83], v[232:235]
    buffer_load_dwordx4 v4, s[8:11], s40 offen offset:2048 lds
    v_mfma_f32_16x16x32_bf16 v[240:243], v[56:59], v[80:83], v[240:243]
    ds_read_b64_tr_b16 v[44:45], v17 offset:32768
    v_mfma_f32_16x16x32_bf16 v[248:251], v[60:63], v[80:83], v[248:251]
    ds_read_b128 v[80:83], v12 offset:8192
    v_mfma_f32_16x16x32_bf16 v[252:255], v[60:63], v[84:87], v[252:255]
    ds_read_b64_tr_b16 v[46:47], v17 offset:33280
    v_mfma_f32_16x16x32_bf16 v[244:247], v[56:59], v[84:87], v[244:247]
    buffer_load_dwordx4 v5, s[8:11], s40 offen offset:3072 lds
    v_mfma_f32_16x16x32_bf16 v[236:239], v[52:55], v[84:87], v[236:239]
    v_mfma_f32_16x16x32_bf16 v[228:231], v[48:51], v[84:87], v[228:231]
    ds_read_b128 v[84:87], v12 offset:10240
    s_waitcnt lgkmcnt(1)
    v_mfma_f32_16x16x32_bf16 v[160:163], v[32:35], v[64:67], v[160:163]
    ds_read_b64_tr_b16 v[48:49], v16 offset:28672
    v_add_u32 v12, s47, v12
    v_mfma_f32_16x16x32_bf16 v[168:171], v[36:39], v[64:67], v[168:171]
    ds_read_b64_tr_b16 v[50:51], v16 offset:29184
    s_add_u32 m0, s42, s3
    v_mfma_f32_16x16x32_bf16 v[176:179], v[40:43], v[64:67], v[176:179]
    buffer_load_dwordx4 v2, s[8:11], s57 offen offset:0 lds
    v_mfma_f32_16x16x32_bf16 v[184:187], v[44:47], v[64:67], v[184:187]
    ds_read_b128 v[64:67], v13 offset:0
    v_mfma_f32_16x16x32_bf16 v[188:191], v[44:47], v[68:71], v[188:191]
    ds_read_b64_tr_b16 v[52:53], v16 offset:36864
    v_mfma_f32_16x16x32_bf16 v[180:183], v[40:43], v[68:71], v[180:183]
    ds_read_b64_tr_b16 v[54:55], v16 offset:37376
    v_mfma_f32_16x16x32_bf16 v[172:175], v[36:39], v[68:71], v[172:175]
    buffer_load_dwordx4 v3, s[8:11], s57 offen offset:1024 lds
    v_add_u32 v16, s47, v16
    v_mfma_f32_16x16x32_bf16 v[164:167], v[32:35], v[68:71], v[164:167]
    ds_read_b128 v[68:71], v13 offset:2048
    s_add_u32 s40, s40, 128
    v_mfma_f32_16x16x32_bf16 v[192:195], v[32:35], v[72:75], v[192:195]
    ds_read_b64_tr_b16 v[56:57], v17 offset:28672
    v_mfma_f32_16x16x32_bf16 v[200:203], v[36:39], v[72:75], v[200:203]
    ds_read_b64_tr_b16 v[58:59], v17 offset:29184
    s_add_u32 m0, s42, s44
    v_mfma_f32_16x16x32_bf16 v[208:211], v[40:43], v[72:75], v[208:211]
    buffer_load_dwordx4 v6, s[12:15], s41 offen offset:0 lds
    v_mfma_f32_16x16x32_bf16 v[216:219], v[44:47], v[72:75], v[216:219]
    ds_read_b128 v[72:75], v13 offset:4096
    v_mfma_f32_16x16x32_bf16 v[220:223], v[44:47], v[76:79], v[220:223]
    ds_read_b64_tr_b16 v[60:61], v17 offset:36864
    v_mfma_f32_16x16x32_bf16 v[212:215], v[40:43], v[76:79], v[212:215]
    ds_read_b64_tr_b16 v[62:63], v17 offset:37376
    v_mfma_f32_16x16x32_bf16 v[204:207], v[36:39], v[76:79], v[204:207]
    buffer_load_dwordx4 v7, s[12:15], s41 offen offset:1024 lds
    v_add_u32 v17, s47, v17
    v_mfma_f32_16x16x32_bf16 v[196:199], v[32:35], v[76:79], v[196:199]
    ds_read_b128 v[76:79], v13 offset:6144
    v_mfma_f32_16x16x32_bf16 v[224:227], v[32:35], v[80:83], v[224:227]
    s_cmp_eq_u32 s40, s55
    s_cselect_b32 s40, s50, s40
    s_cselect_b32 s99, s98, s100
    v_mfma_f32_16x16x32_bf16 v[232:235], v[36:39], v[80:83], v[232:235]
    s_add_u32 m0, s42, s45
    s_add_u32 s57, s40, 40960
    v_mfma_f32_16x16x32_bf16 v[240:243], v[40:43], v[80:83], v[240:243]
    buffer_load_dwordx4 v6, s[16:19], s41 offen offset:0 lds
    v_mfma_f32_16x16x32_bf16 v[248:251], v[44:47], v[80:83], v[248:251]
    ds_read_b128 v[80:83], v13 offset:8192
    s_waitcnt lgkmcnt(13)
    v_mfma_f32_16x16x32_bf16 v[252:255], v[44:47], v[84:87], v[252:255]
    s_add_u32 s42, s42, 40960
    s_cmp_eq_u32 s42, 122880
    s_cselect_b32 s42, 0, s42
    v_mfma_f32_16x16x32_bf16 v[244:247], v[40:43], v[84:87], v[244:247]
    v_mfma_f32_16x16x32_bf16 v[236:239], v[36:39], v[84:87], v[236:239]
    buffer_load_dwordx4 v7, s[16:19], s41 offen offset:1024 lds
    v_mfma_f32_16x16x32_bf16 v[228:231], v[32:35], v[84:87], v[228:231]
    ds_read_b128 v[84:87], v13 offset:10240
    s_add_u32 s41, s41, s99
    s_waitcnt lgkmcnt(3)
    v_mfma_f32_16x16x32_bf16 v[160:163], v[48:51], v[64:67], v[160:163]
    v_add_u32 v13, s47, v13
    v_mfma_f32_16x16x32_bf16 v[168:171], v[52:55], v[64:67], v[168:171]
    v_mfma_f32_16x16x32_bf16 v[176:179], v[56:59], v[64:67], v[176:179]
    buffer_load_dword v91, v90, s[92:95], s88 offen
    s_add_u32 s88, s88, s89
    v_mfma_f32_16x16x32_bf16 v[184:187], v[60:63], v[64:67], v[184:187]
    s_cmp_ge_u32 s88, s90
    s_cselect_b32 s88, 0x40000000, s88
    v_mfma_f32_16x16x32_bf16 v[188:191], v[60:63], v[68:71], v[188:191]
    s_cmp_lg_u32 s48, 0
    s_waitcnt vmcnt(12) lgkmcnt(0)
    s_barrier
    s_cbranch_scc1 LT_loop
LT_post:
    v_cmp_eq_u32 vcc, 0, v25
    s_nop 1
    s_cbranch_vccnz LT_tag_again
LT_tag_ok:
    v_mfma_f32_16x16x32_bf16 v[180:183], v[56:59], v[68:71], v[180:183]
    ds_read_b128 v[64:67], v12 offset:0
    v_lshrrev_b32 v107, 5, v1
    v_mfma_f32_16x16x32_bf16 v[172:175], v[52:55], v[68:71], v[172:175]
    ds_read_b64_tr_b16 v[32:33], v16 offset:24576
    v_mul_u32_u24 v107, 49152, v107
LT_hop0:
    s_cbranch_execz LT_back
    v_mfma_f32_16x16x32_bf16 v[164:167], v[48:51], v[68:71], v[164:167]
    ds_read_b128 v[68:71], v12 offset:2048
    s_add_u32 s46, s46, 40960
    s_cmp_eq_u32 s46, 122880
    v_mfma_f32_16x16x32_bf16 v[192:195], v[48:51], v[72:75], v[192:195]
    s_cselect_b32 s47, 0xfffec000, s49
    s_cselect_b32 s46, 0, s46
    ds_read_b64_tr_b16 v[34:35], v16 offset:25088
    v_mfma_f32_16x16x32_bf16 v[200:203], v[52:55], v[72:75], v[200:203]
    ds_read_b64_tr_b16 v[36:37], v16 offset:32768
    v_and_b32 v108, 31, v1
    v_mfma_f32_16x16x32_bf16 v[208:211], v[56:59], v[72:75], v[208:211]
    ds_read_b64_tr_b16 v[38:39], v16 offset:33280
    v_lshl_add_u32 v19, v108, 4, v107
    v_mfma_f32_16x16x32_bf16 v[216:219], v[60:63], v[72:75], v[216:219]
    ds_read_b128 v[72:75], v12 offset:4096
    v_mov_b32 v20, 0xbdd2d3e8
    v_mfma_f32_16x16x32_bf16 v[220:223], v[60:63], v[76:79], v[220:223]
    ds_read_b64_tr_b16 v[40:41], v17 offset:24576
    v_mov_b32 v21, 0xbdd2d3e8
    v_mfma_f32_16x16x32_bf16 v[212:215], v[56:59], v[76:79], v[212:215]
    ds_read_b64_tr_b16 v[42:43], v17 offset:25088
    v_mov_b32 v22, 0xc0135761
    v_mfma_f32_16x16x32_bf16 v[204:207], v[52:55], v[76:79], v[204:207]
    ds_read_b64_tr_b16 v[44:45], v17 offset:32768
    v_mov_b32 v23, 0xc0135761
    v_mfma_f32_16x16x32_bf16 v[196:199], v[48:51], v[76:79], v[196:199]
    ds_read_b128 v[76:79], v12 offset:6144
    v_and_b32 v107, 1, v1
    s_lshl_b32 s60, s37, 1
    v_mfma_f32_16x16x32_bf16 v[224:227], v[48:51], v[80:83], v[224:227]
    ds_read_b64_tr_b16 v[46:47], v17 offset:33280
    s_add_u32 s60, s60, s63
    s_mul_i32 s60, s60, 3
    v_mfma_f32_16x16x32_bf16 v[232:235], v[52:55], v[80:83], v[232:235]
    s_add_u32 m0, s7, 122880
    s_nop 0
    buffer_load_dwordx4 v9, s[20:23], s56 offen offset:0 lds
    s_mul_i32 s88, s60, 98304
    s_lshl_b32 s61, s38, 1
    v_mfma_f32_16x16x32_bf16 v[240:243], v[56:59], v[80:83], v[240:243]
    buffer_load_dwordx4 v10, s[20:23], s56 offen offset:1024 lds
    s_add_u32 s61, s61, s64
    s_lshl_b32 s61, s61, 10
    v_mfma_f32_16x16x32_bf16 v[248:251], v[60:63], v[80:83], v[248:251]
    ds_read_b128 v[80:83], v12 offset:8192
    s_add_u32 s88, s88, s61
    v_mfma_f32_16x16x32_bf16 v[252:255], v[60:63], v[84:87], v[252:255]
    buffer_load_dwordx4 v11, s[20:23], s56 offen offset:2048 lds
    s_add_u32 s89, s88, 512
    s_add_u32 s90, s88, 98304
    v_mfma_f32_16x16x32_bf16 v[244:247], v[56:59], v[84:87], v[244:247]
    s_add_u32 s91, s89, 98304
    s_add_u32 s92, s88, 196608
    s_add_u32 s93, s89, 196608
    v_mfma_f32_16x16x32_bf16 v[236:239], v[52:55], v[84:87], v[236:239]
    buffer_load_dwordx4 v14, s[20:23], s56 offen offset:3072 lds
    s_lshl_b32 s60, s60, 2
    s_add_u32 s60, s60, s4
    v_mfma_f32_16x16x32_bf16 v[228:231], v[48:51], v[84:87], v[228:231]
    ds_read_b128 v[84:87], v12 offset:10240
    s_lshl_b32 s60, s60, 4
    s_waitcnt lgkmcnt(2)
    v_mfma_f32_16x16x32_bf16 v[160:163], v[32:35], v[64:67], v[160:163]
    ds_read_b64_tr_b16 v[48:49], v16 offset:28672
    v_add_u32 v12, s47, v12
    s_lshl_b32 s61, s5, 1
    v_mfma_f32_16x16x32_bf16 v[168:171], v[36:39], v[64:67], v[168:171]
    ds_read_b64_tr_b16 v[50:51], v16 offset:29184
    s_add_u32 s61, s61, s64
    s_add_u32 s60, s60, s61
    v_mfma_f32_16x16x32_bf16 v[176:179], v[40:43], v[64:67], v[176:179]
    ds_read_b64_tr_b16 v[52:53], v16 offset:36864
    s_lshl_b32 s60, s60, 3
    s_add_u32 s60, s60, 6291456
    v_mfma_f32_16x16x32_bf16 v[184:187], v[44:47], v[64:67], v[184:187]
    ds_read_b128 v[64:67], v13 offset:0
    v_lshlrev_b32 v107, 9, v107
    v_mfma_f32_16x16x32_bf16 v[188:191], v[44:47], v[68:71], v[188:191]
    ds_read_b64_tr_b16 v[54:55], v16 offset:37376
    v_add_u32 v133, s60, v107
    s_add_u32 s60, s60, 1024
    v_mfma_f32_16x16x32_bf16 v[180:183], v[40:43], v[68:71], v[180:183]
    ds_read_b64_tr_b16 v[56:57], v17 offset:28672
    v_add_u32 v16, s47, v16
    v_mfma_f32_16x16x32_bf16 v[172:175], v[36:39], v[68:71], v[172:175]
    ds_read_b64_tr_b16 v[58:59], v17 offset:29184
    v_mov_b32 v134, s60
    v_mfma_f32_16x16x32_bf16 v[164:167], v[32:35], v[68:71], v[164:167]
    ds_read_b128 v[68:71], v13 offset:2048
    v_mfma_f32_16x16x32_bf16 v[192:195], v[32:35], v[72:75], v[192:195]
    ds_read_b64_tr_b16 v[60:61], v17 offset:36864
    v_mfma_f32_16x16x32_bf16 v[200:203], v[36:39], v[72:75], v[200:203]
    ds_read_b64_tr_b16 v[62:63], v17 offset:37376
    v_mfma_f32_16x16x32_bf16 v[208:211], v[40:43], v[72:75], v[208:211]
    s_add_u32 m0, s7, 126976
    s_add_u32 s56, s56, 40960
    buffer_load_dwordx4 v9, s[20:23], s56 offen offset:0 lds
    v_add_u32 v17, s47, v17
    v_mfma_f32_16x16x32_bf16 v[216:219], v[44:47], v[72:75], v[216:219]
    ds_read_b128 v[72:75], v13 offset:4096
    s_waitcnt lgkmcnt(12)
    v_mfma_f32_16x16x32_bf16 v[220:223], v[44:47], v[76:79], v[220:223]
    buffer_load_dwordx4 v10, s[20:23], s56 offen offset:1024 lds
    v_mfma_f32_16x16x32_bf16 v[212:215], v[40:43], v[76:79], v[212:215]
    v_mfma_f32_16x16x32_bf16 v[204:207], v[36:39], v[76:79], v[204:207]
    v_mfma_f32_16x16x32_bf16 v[196:199], v[32:35], v[76:79], v[196:199]
    ds_read_b128 v[76:79], v13 offset:6144
    v_mfma_f32_16x16x32_bf16 v[224:227], v[32:35], v[80:83], v[224:227]
    buffer_load_dwordx4 v11, s[20:23], s56 offen offset:2048 lds
    v_mfma_f32_16x16x32_bf16 v[232:235], v[36:39], v[80:83], v[232:235]
    v_mfma_f32_16x16x32_bf16 v[240:243], v[40:43], v[80:83], v[240:243]
    v_mfma_f32_16x16x32_bf16 v[248:251], v[44:47], v[80:83], v[248:251]
    ds_read_b128 v[80:83], v13 offset:8192
    s_waitcnt lgkmcnt(13)
    v_mfma_f32_16x16x32_bf16 v[252:255], v[44:47], v[84:87], v[252:255]
    v_mfma_f32_16x16x32_bf16 v[244:247], v[40:43], v[84:87], v[244:247]
    v_mfma_f32_16x16x32_bf16 v[236:239], v[36:39], v[84:87], v[236:239]
    buffer_load_dwordx4 v14, s[20:23], s56 offen offset:3072 lds
    v_mfma_f32_16x16x32_bf16 v[228:231], v[32:35], v[84:87], v[228:231]
    ds_read_b128 v[84:87], v13 offset:10240
    s_waitcnt lgkmcnt(3)
    v_mfma_f32_16x16x32_bf16 v[160:163], v[48:51], v[64:67], v[160:163]
    v_add_u32 v13, s47, v13
    v_mfma_f32_16x16x32_bf16 v[168:171], v[52:55], v[64:67], v[168:171]
    v_mfma_f32_16x16x32_bf16 v[176:179], v[56:59], v[64:67], v[176:179]
    v_mfma_f32_16x16x32_bf16 v[184:187], v[60:63], v[64:67], v[184:187]
    v_mfma_f32_16x16x32_bf16 v[188:191], v[60:63], v[68:71], v[188:191]
    s_waitcnt vmcnt(9) lgkmcnt(0)
    s_barrier
    v_mfma_f32_16x16x32_bf16 v[180:183], v[56:59], v[68:71], v[180:183]
    ds_read_b128 v[64:67], v12 offset:0
    s_lshr_b32 s60, s83, 8
    s_and_b32 s83, s83, 7
    v_mfma_f32_16x16x32_bf16 v[172:175], v[52:55], v[68:71], v[172:175]
    ds_read_b64_tr_b16 v[32:33], v16 offset:24576
    v_lshrrev_b32 v107, 4, v1
    v_mfma_f32_16x16x32_bf16 v[164:167], v[48:51], v[68:71], v[164:167]
    ds_read_b128 v[68:71], v12 offset:2048
    v_min_u32 v107, s60, v107
    v_mfma_f32_16x16x32_bf16 v[192:195], v[48:51], v[72:75], v[192:195]
    ds_read_b64_tr_b16 v[34:35], v16 offset:25088
    v_and_b32 v108, 15, v1
    v_mfma_f32_16x16x32_bf16 v[200:203], v[52:55], v[72:75], v[200:203]
    ds_read_b64_tr_b16 v[36:37], v16 offset:32768
    v_min_u32 v108, 11, v108
    v_mfma_f32_16x16x32_bf16 v[208:211], v[56:59], v[72:75], v[208:211]
    ds_read_b64_tr_b16 v[38:39], v16 offset:33280
    v_lshlrev_b32 v108, 3, v108
    s_lshl_b32 s60, s36, 7
    v_mfma_f32_16x16x32_bf16 v[216:219], v[60:63], v[72:75], v[216:219]
    ds_read_b128 v[72:75], v12 offset:4096
    s_add_u32 s60, s60, s82
    v_mfma_f32_16x16x32_bf16 v[220:223], v[60:63], v[76:79], v[220:223]
    ds_read_b64_tr_b16 v[40:41], v17 offset:24576
    s_add_u32 s60, s60, 6291456
    v_add_u32 v108, s60, v108
    v_mfma_f32_16x16x32_bf16 v[212:215], v[56:59], v[76:79], v[212:215]
    ds_read_b64_tr_b16 v[42:43], v17 offset:25088
    v_lshl_add_u32 v29, v107, 9, v108
    v_mfma_f32_16x16x32_bf16 v[204:207], v[52:55], v[76:79], v[204:207]
    ds_read_b64_tr_b16 v[44:45], v17 offset:32768
    v_cmp_gt_u32 vcc, 32, v1
    v_mfma_f32_16x16x32_bf16 v[196:199], v[48:51], v[76:79], v[196:199]
    ds_read_b128 v[76:79], v12 offset:6144
    v_mov_b32 v107, s68
    v_mfma_f32_16x16x32_bf16 v[224:227], v[48:51], v[80:83], v[224:227]
    ds_read_b64_tr_b16 v[46:47], v17 offset:33280
    v_mov_b32 v109, s69
    v_mfma_f32_16x16x32_bf16 v[232:235], v[52:55], v[80:83], v[232:235]
    s_add_u32 m0, s7, 40960
    s_add_u32 s56, s56, 40960
    buffer_load_dwordx4 v9, s[20:23], s56 offen offset:0 lds
    v_cndmask_b32 v107, v109, v107, vcc
    v_mfma_f32_16x16x32_bf16 v[240:243], v[56:59], v[80:83], v[240:243]
    buffer_load_dwordx4 v10, s[20:23], s56 offen offset:1024 lds
    v_add_u32 v28, v107, v108
    s_add_u32 s62, s7, 40960
    v_mfma_f32_16x16x32_bf16 v[248:251], v[60:63], v[80:83], v[248:251]
    ds_read_b128 v[80:83], v12 offset:8192
    v_and_b32 v107, 15, v1
    v_mfma_f32_16x16x32_bf16 v[252:255], v[60:63], v[84:87], v[252:255]
    buffer_load_dwordx4 v11, s[20:23], s56 offen offset:2048 lds
    v_mul_u32_u24 v107, 272, v107
    v_mfma_f32_16x16x32_bf16 v[244:247], v[56:59], v[84:87], v[244:247]
    buffer_load_dwordx4 v14, s[20:23], s56 offen offset:3072 lds
    v_lshrrev_b32 v108, 4, v1
    v_mfma_f32_16x16x32_bf16 v[236:239], v[52:55], v[84:87], v[236:239]
    s_add_u32 m0, s7, 45056
    s_add_u32 s56, s56, 40960
    buffer_load_dwordx4 v9, s[20:23], s56 offen offset:0 lds
    v_lshl_add_u32 v107, v108, 4, v107
    v_mfma_f32_16x16x32_bf16 v[228:231], v[48:51], v[84:87], v[228:231]
    ds_read_b128 v[84:87], v12 offset:10240
    v_add_u32 v96, s62, v107
    s_waitcnt lgkmcnt(2)
    v_mfma_f32_16x16x32_bf16 v[160:163], v[32:35], v[64:67], v[160:163]
    ds_read_b64_tr_b16 v[48:49], v16 offset:28672
    v_and_b32 v109, 15, v1
    s_mul_i32 s62, s36, 1088
    v_mfma_f32_16x16x32_bf16 v[168:171], v[36:39], v[64:67], v[168:171]
    ds_read_b64_tr_b16 v[50:51], v16 offset:29184
    s_add_u32 s62, s62, 40960
    v_mul_u32_u24 v107, 272, v108
    v_mfma_f32_16x16x32_bf16 v[176:179], v[40:43], v[64:67], v[176:179]
    ds_read_b64_tr_b16 v[52:53], v16 offset:36864
    v_lshl_add_u32 v107, v109, 4, v107
    v_mfma_f32_16x16x32_bf16 v[184:187], v[44:47], v[64:67], v[184:187]
    ds_read_b128 v[64:67], v13 offset:0
    v_add_u32 v97, s62, v107
    v_mfma_f32_16x16x32_bf16 v[188:191], v[44:47], v[68:71], v[188:191]
    ds_read_b64_tr_b16 v[54:55], v16 offset:37376
    v_mul_u32_u24 v108, 1280, v108
    v_mfma_f32_16x16x32_bf16 v[180:183], v[40:43], v[68:71], v[180:183]
    ds_read_b64_tr_b16 v[56:57], v17 offset:28672
    v_lshl_add_u32 v98, v109, 3, v108
    s_mul_i32 s60, s36, 5120
    v_mfma_f32_16x16x32_bf16 v[172:175], v[36:39], v[68:71], v[172:175]
    ds_read_b64_tr_b16 v[58:59], v17 offset:29184
    s_lshl_b32 s61, s101, 7
    s_add_u32 s60, s60, s61
    v_mfma_f32_16x16x32_bf16 v[164:167], v[32:35], v[68:71], v[164:167]
    ds_read_b128 v[68:71], v13 offset:2048
    v_add_u32 v98, s60, v98
    v_mfma_f32_16x16x32_bf16 v[192:195], v[32:35], v[72:75], v[192:195]
    ds_read_b64_tr_b16 v[60:61], v17 offset:36864
    v_mfma_f32_16x16x32_bf16 v[200:203], v[36:39], v[72:75], v[200:203]
    ds_read_b64_tr_b16 v[62:63], v17 offset:37376
    v_mfma_f32_16x16x32_bf16 v[208:211], v[40:43], v[72:75], v[208:211]
    buffer_load_dwordx4 v10, s[20:23], s56 offen offset:1024 lds
    v_mfma_f32_16x16x32_bf16 v[216:219], v[44:47], v[72:75], v[216:219]
    ds_read_b128 v[72:75], v13 offset:4096
    s_waitcnt lgkmcnt(12)
    v_mfma_f32_16x16x32_bf16 v[220:223], v[44:47], v[76:79], v[220:223]
    buffer_load_dwordx4 v11, s[20:23], s56 offen offset:2048 lds
    v_mfma_f32_16x16x32_bf16 v[212:215], v[40:43], v[76:79], v[212:215]
    buffer_load_dwordx4 v14, s[20:23], s56 offen offset:3072 lds
    v_mfma_f32_16x16x32_bf16 v[204:207], v[36:39], v[76:79], v[204:207]
    s_add_u32 m0, s7, 81920
    s_add_u32 s56, s56, 40960
    buffer_load_dwordx4 v9, s[20:23], s56 offen offset:0 lds
    v_mfma_f32_16x16x32_bf16 v[196:199], v[32:35], v[76:79], v[196:199]
    ds_read_b128 v[76:79], v13 offset:6144
    v_mfma_f32_16x16x32_bf16 v[224:227], v[32:35], v[80:83], v[224:227]
    v_mfma_f32_16x16x32_bf16 v[232:235], v[36:39], v[80:83], v[232:235]
    v_mfma_f32_16x16x32_bf16 v[240:243], v[40:43], v[80:83], v[240:243]
    buffer_load_dwordx4 v10, s[20:23], s56 offen offset:1024 lds
    v_mfma_f32_16x16x32_bf16 v[248:251], v[44:47], v[80:83], v[248:251]
    ds_read_b128 v[80:83], v13 offset:8192
    s_waitcnt lgkmcnt(13)
    v_mfma_f32_16x16x32_bf16 v[252:255], v[44:47], v[84:87], v[252:255]
    v_mfma_f32_16x16x32_bf16 v[244:247], v[40:43], v[84:87], v[244:247]
    s_waitcnt vmcnt(14)
    ds_read_b64_tr_b16 a[0:1], v99 offset:57344
    v_mfma_f32_16x16x32_bf16 v[236:239], v[36:39], v[84:87], v[236:239]
    ds_read_b64_tr_b16 a[2:3], v99 offset:58368
    v_mfma_f32_16x16x32_bf16 v[228:231], v[32:35], v[84:87], v[228:231]
    ds_read_b128 v[84:87], v13 offset:10240
    s_waitcnt lgkmcnt(12)
    v_mfma_f32_16x16x32_bf16 v[160:163], v[48:51], v[64:67], v[160:163]
    s_waitcnt lgkmcnt(11)
    v_mfma_f32_16x16x32_bf16 v[168:171], v[52:55], v[64:67], v[168:171]
    s_waitcnt lgkmcnt(9)
    v_mfma_f32_16x16x32_bf16 v[176:179], v[56:59], v[64:67], v[176:179]
    ds_read_b64_tr_b16 a[4:5], v104 offset:57344
    s_waitcnt lgkmcnt(7)
    v_mfma_f32_16x16x32_bf16 v[184:187], v[60:63], v[64:67], v[184:187]
    ds_read_b64_tr_b16 a[6:7], v104 offset:58368
    v_mfma_f32_16x16x32_bf16 v[188:191], v[60:63], v[68:71], v[188:191]
    ds_read_b64_tr_b16 a[8:9], v105 offset:57344
    v_mfma_f32_16x16x32_bf16 v[180:183], v[56:59], v[68:71], v[180:183]
    ds_read_b64_tr_b16 a[10:11], v105 offset:58368
    v_mfma_f32_16x16x32_bf16 v[172:175], v[52:55], v[68:71], v[172:175]
    ds_read_b64_tr_b16 a[12:13], v106 offset:57344
    v_mfma_f32_16x16x32_bf16 v[164:167], v[48:51], v[68:71], v[164:167]
    ds_read_b64_tr_b16 a[14:15], v106 offset:58368
    s_waitcnt lgkmcnt(11)
    v_mfma_f32_16x16x32_bf16 v[192:195], v[48:51], v[72:75], v[192:195]
    v_mfma_f32_16x16x32_bf16 v[200:203], v[52:55], v[72:75], v[200:203]
    v_mfma_f32_16x16x32_bf16 v[208:211], v[56:59], v[72:75], v[208:211]
    v_mfma_f32_16x16x32_bf16 v[216:219], v[60:63], v[72:75], v[216:219]
    s_waitcnt lgkmcnt(10)
    v_mfma_f32_16x16x32_bf16 v[220:223], v[60:63], v[76:79], v[220:223]
    v_mfma_f32_16x16x32_bf16 v[212:215], v[56:59], v[76:79], v[212:215]
    v_mfma_f32_16x16x32_bf16 v[204:207], v[52:55], v[76:79], v[204:207]
    v_mfma_f32_16x16x32_bf16 v[196:199], v[48:51], v[76:79], v[196:199]
    s_waitcnt lgkmcnt(9)
    v_mfma_f32_16x16x32_bf16 v[224:227], v[48:51], v[80:83], v[224:227]
    v_mfma_f32_16x16x32_bf16 v[232:235], v[52:55], v[80:83], v[232:235]
    v_mfma_f32_16x16x32_bf16 v[240:243], v[56:59], v[80:83], v[240:243]
    v_mfma_f32_16x16x32_bf16 v[248:251], v[60:63], v[80:83], v[248:251]
    s_waitcnt lgkmcnt(6)
    v_mfma_f32_16x16x32_bf16 v[252:255], v[60:63], v[84:87], v[252:255]
    v_mfma_f32_16x16x32_bf16 v[244:247], v[56:59], v[84:87], v[244:247]
    v_mfma_f32_16x16x32_bf16 v[236:239], v[52:55], v[84:87], v[236:239]
    v_mfma_f32_16x16x32_bf16 v[228:231], v[48:51], v[84:87], v[228:231]
L_gate:
LW_hopB:
    s_cbranch_execz LW_back
    v_pk_mul_f32 v[32:33], v[160:161], v[160:161]
    v_pk_mul_f32 v[34:35], v[162:163], v[162:163]
    v_pk_mul_f32 v[36:37], v[164:165], v[164:165]
    v_pk_mul_f32 v[38:39], v[166:167], v[166:167]
    v_pk_fma_f32 v[32:33], v[32:33], v[20:21], v[22:23]
    v_pk_fma_f32 v[34:35], v[34:35], v[20:21], v[22:23]
    v_pk_fma_f32 v[36:37], v[36:37], v[20:21], v[22:23]
    v_pk_fma_f32 v[38:39], v[38:39], v[20:21], v[22:23]
    v_pk_mul_f32 v[32:33], v[32:33], v[160:161]
    v_pk_mul_f32 v[34:35], v[34:35], v[162:163]
    v_pk_mul_f32 v[36:37], v[36:37], v[164:165]
    v_pk_mul_f32 v[38:39], v[38:39], v[166:167]
    v_exp_f32 v32, v32
    v_exp_f32 v33, v33
    v_exp_f32 v34, v34
    v_exp_f32 v35, v35
    v_exp_f32 v36, v36
    v_pk_add_f32 v[32:33], v[32:33], 1.0 op_sel_hi:[1,0]
    v_exp_f32 v37, v37
    v_pk_add_f32 v[34:35], v[34:35], 1.0 op_sel_hi:[1,0]
    v_exp_f32 v38, v38
    v_pk_add_f32 v[36:37], v[36:37], 1.0 op_sel_hi:[1,0]
    v_exp_f32 v39, v39
    s_nop 0
    v_pk_add_f32 v[38:39], v[38:39], 1.0 op_sel_hi:[1,0]
    buffer_load_dwordx4 v11, s[20:23], s56 offen offset:2048 lds
    v_rcp_f32 v32, v32
    v_pk_mul_f32 v[40:41], v[176:177], v[176:177]
    v_pk_mul_f32 v[42:43], v[178:179], v[178:179]
    v_rcp_f32 v33, v33
    v_pk_mul_f32 v[44:45], v[180:181], v[180:181]
    v_pk_mul_f32 v[46:47], v[182:183], v[182:183]
    v_rcp_f32 v34, v34
    v_pk_fma_f32 v[40:41], v[40:41], v[20:21], v[22:23]
    v_pk_fma_f32 v[42:43], v[42:43], v[20:21], v[22:23]
    v_rcp_f32 v35, v35
    v_pk_fma_f32 v[44:45], v[44:45], v[20:21], v[22:23]
    v_pk_fma_f32 v[46:47], v[46:47], v[20:21], v[22:23]
    v_rcp_f32 v36, v36
    v_pk_mul_f32 v[40:41], v[40:41], v[176:177]
    v_rcp_f32 v37, v37
    v_pk_mul_f32 v[42:43], v[42:43], v[178:179]
    v_rcp_f32 v38, v38
    v_pk_mul_f32 v[44:45], v[44:45], v[180:181]
    v_rcp_f32 v39, v39
    v_pk_mul_f32 v[46:47], v[46:47], v[182:183]
    s_waitcnt vmcnt(11)
    ds_read_b64_tr_b16 a[16:17], v99 offset:61440
    ds_read_b64_tr_b16 a[18:19], v99 offset:62464
    v_exp_f32 v40, v40
    v_pk_mul_f32 v[32:33], v[32:33], v[160:161]
    v_pk_mul_f32 v[34:35], v[34:35], v[162:163]
    v_exp_f32 v41, v41
    v_pk_mul_f32 v[36:37], v[36:37], v[164:165]
    v_pk_mul_f32 v[38:39], v[38:39], v[166:167]
    v_exp_f32 v42, v42
    v_pk_mul_f32 v[32:33], v[32:33], v[168:169]
    v_pk_mul_f32 v[34:35], v[34:35], v[170:171]
    v_exp_f32 v43, v43
    v_pk_mul_f32 v[36:37], v[36:37], v[172:173]
    v_pk_mul_f32 v[38:39], v[38:39], v[174:175]
    v_exp_f32 v44, v44
    v_cvt_pk_bf16_f32 v112, v32, v33
    v_pk_add_f32 v[40:41], v[40:41], 1.0 op_sel_hi:[1,0]
    v_exp_f32 v45, v45
    v_cvt_pk_bf16_f32 v114, v36, v37
    v_pk_add_f32 v[42:43], v[42:43], 1.0 op_sel_hi:[1,0]
    v_exp_f32 v46, v46
    v_cvt_pk_bf16_f32 v113, v34, v35
    v_pk_add_f32 v[44:45], v[44:45], 1.0 op_sel_hi:[1,0]
    v_exp_f32 v47, v47
    v_cvt_pk_bf16_f32 v115, v38, v39
    v_permlane32_swap_b32 v112, v114
    v_pk_add_f32 v[46:47], v[46:47], 1.0 op_sel_hi:[1,0]
    v_permlane32_swap_b32 v113, v115
    buffer_store_dwordx4 v[112:115], v19, s[24:27], s88 offen sc1
    buffer_load_dwordx4 v14, s[20:23], s56 offen offset:3072 lds
    v_rcp_f32 v40, v40
    v_pk_mul_f32 v[32:33], v[192:193], v[192:193]
    v_pk_mul_f32 v[34:35], v[194:195], v[194:195]
    v_rcp_f32 v41, v41
    v_pk_mul_f32 v[36:37], v[196:197], v[196:197]
    v_pk_mul_f32 v[38:39], v[198:199], v[198:199]
    v_rcp_f32 v42, v42
    v_pk_fma_f32 v[32:33], v[32:33], v[20:21], v[22:23]
    v_pk_fma_f32 v[34:35], v[34:35], v[20:21], v[22:23]
    v_rcp_f32 v43, v43
    v_pk_fma_f32 v[36:37], v[36:37], v[20:21], v[22:23]
    v_pk_fma_f32 v[38:39], v[38:39], v[20:21], v[22:23]
    v_rcp_f32 v44, v44
    v_pk_mul_f32 v[32:33], v[32:33], v[192:193]
    v_rcp_f32 v45, v45
    v_pk_mul_f32 v[34:35], v[34:35], v[194:195]
    v_rcp_f32 v46, v46
    v_pk_mul_f32 v[36:37], v[36:37], v[196:197]
    v_rcp_f32 v47, v47
    v_pk_mul_f32 v[38:39], v[38:39], v[198:199]
    ds_read_b64_tr_b16 a[20:21], v104 offset:61440
    v_exp_f32 v32, v32
    v_pk_mul_f32 v[40:41], v[40:41], v[176:177]
    v_pk_mul_f32 v[42:43], v[42:43], v[178:179]
    v_exp_f32 v33, v33
    v_pk_mul_f32 v[44:45], v[44:45], v[180:181]
    v_pk_mul_f32 v[46:47], v[46:47], v[182:183]
    v_exp_f32 v34, v34
    v_pk_mul_f32 v[40:41], v[40:41], v[184:185]
    v_pk_mul_f32 v[42:43], v[42:43], v[186:187]
    v_exp_f32 v35, v35
    v_pk_mul_f32 v[44:45], v[44:45], v[188:189]
    v_pk_mul_f32 v[46:47], v[46:47], v[190:191]
    v_exp_f32 v36, v36
    v_cvt_pk_bf16_f32 v116, v40, v41
    v_pk_add_f32 v[32:33], v[32:33], 1.0 op_sel_hi:[1,0]
    v_exp_f32 v37, v37
    v_cvt_pk_bf16_f32 v118, v44, v45
    v_pk_add_f32 v[34:35], v[34:35], 1.0 op_sel_hi:[1,0]
    v_exp_f32 v38, v38
    v_cvt_pk_bf16_f32 v117, v42, v43
    v_pk_add_f32 v[36:37], v[36:37], 1.0 op_sel_hi:[1,0]
    v_exp_f32 v39, v39
    v_cvt_pk_bf16_f32 v119, v46, v47
    v_permlane32_swap_b32 v116, v118
    v_pk_add_f32 v[38:39], v[38:39], 1.0 op_sel_hi:[1,0]
    v_permlane32_swap_b32 v117, v119
    buffer_store_dwordx4 v[116:119], v19, s[24:27], s89 offen sc1
    ds_read_b64_tr_b16 a[22:23], v104 offset:62464
    s_add_u32 m0, s7, 86016
    s_add_u32 s56, s56, 40960
    buffer_load_dwordx4 v9, s[20:23], s56 offen offset:0 lds
    v_rcp_f32 v32, v32
    v_pk_mul_f32 v[40:41], v[208:209], v[208:209]
    v_pk_mul_f32 v[42:43], v[210:211], v[210:211]
    v_rcp_f32 v33, v33
    v_pk_mul_f32 v[44:45], v[212:213], v[212:213]
    v_pk_mul_f32 v[46:47], v[214:215], v[214:215]
    v_rcp_f32 v34, v34
    v_pk_fma_f32 v[40:41], v[40:41], v[20:21], v[22:23]
    v_pk_fma_f32 v[42:43], v[42:43], v[20:21], v[22:23]
    v_rcp_f32 v35, v35
    v_pk_fma_f32 v[44:45], v[44:45], v[20:21], v[22:23]
    v_pk_fma_f32 v[46:47], v[46:47], v[20:21], v[22:23]
    v_rcp_f32 v36, v36
    v_pk_mul_f32 v[40:41], v[40:41], v[208:209]
    v_rcp_f32 v37, v37
    v_pk_mul_f32 v[42:43], v[42:43], v[210:211]
    v_rcp_f32 v38, v38
    v_pk_mul_f32 v[44:45], v[44:45], v[212:213]
    v_rcp_f32 v39, v39
    v_pk_mul_f32 v[46:47], v[46:47], v[214:215]
    v_exp_f32 v40, v40
    v_pk_mul_f32 v[32:33], v[32:33], v[192:193]
    v_pk_mul_f32 v[34:35], v[34:35], v[194:195]
    v_exp_f32 v41, v41
    v_pk_mul_f32 v[36:37], v[36:37], v[196:197]
    v_pk_mul_f32 v[38:39], v[38:39], v[198:199]
    v_exp_f32 v42, v42
    v_pk_mul_f32 v[32:33], v[32:33], v[200:201]
    v_pk_mul_f32 v[34:35], v[34:35], v[202:203]
    v_exp_f32 v43, v43
    v_pk_mul_f32 v[36:37], v[36:37], v[204:205]
    v_pk_mul_f32 v[38:39], v[38:39], v[206:207]
    v_exp_f32 v44, v44
    v_cvt_pk_bf16_f32 v120, v32, v33
    v_pk_add_f32 v[40:41], v[40:41], 1.0 op_sel_hi:[1,0]
    v_exp_f32 v45, v45
    v_cvt_pk_bf16_f32 v122, v36, v37
    v_pk_add_f32 v[42:43], v[42:43], 1.0 op_sel_hi:[1,0]
    v_exp_f32 v46, v46
    v_cvt_pk_bf16_f32 v121, v34, v35
    v_pk_add_f32 v[44:45], v[44:45], 1.0 op_sel_hi:[1,0]
    v_exp_f32 v47, v47
    v_cvt_pk_bf16_f32 v123, v38, v39
    v_permlane32_swap_b32 v120, v122
    v_pk_add_f32 v[46:47], v[46:47], 1.0 op_sel_hi:[1,0]
    v_permlane32_swap_b32 v121, v123
    buffer_store_dwordx4 v[120:123], v19, s[24:27], s90 offen sc1
    ds_read_b64_tr_b16 a[24:25], v105 offset:61440
    buffer_load_dwordx4 v10, s[20:23], s56 offen offset:1024 lds
    v_rcp_f32 v40, v40
    v_pk_mul_f32 v[32:33], v[224:225], v[224:225]
    v_pk_mul_f32 v[34:35], v[226:227], v[226:227]
    v_rcp_f32 v41, v41
    v_pk_mul_f32 v[36:37], v[228:229], v[228:229]
    v_pk_mul_f32 v[38:39], v[230:231], v[230:231]
    v_rcp_f32 v42, v42
    v_pk_fma_f32 v[32:33], v[32:33], v[20:21], v[22:23]
    v_pk_fma_f32 v[34:35], v[34:35], v[20:21], v[22:23]
    v_rcp_f32 v43, v43
    v_pk_fma_f32 v[36:37], v[36:37], v[20:21], v[22:23]
    v_pk_fma_f32 v[38:39], v[38:39], v[20:21], v[22:23]
    v_rcp_f32 v44, v44
    v_pk_mul_f32 v[32:33], v[32:33], v[224:225]
    v_rcp_f32 v45, v45
    v_pk_mul_f32 v[34:35], v[34:35], v[226:227]
    v_rcp_f32 v46, v46
    v_pk_mul_f32 v[36:37], v[36:37], v[228:229]
    v_rcp_f32 v47, v47
    v_pk_mul_f32 v[38:39], v[38:39], v[230:231]
    ds_read_b64_tr_b16 a[26:27], v105 offset:62464
    v_exp_f32 v32, v32
    v_pk_mul_f32 v[40:41], v[40:41], v[208:209]
    v_pk_mul_f32 v[42:43], v[42:43], v[210:211]
    v_exp_f32 v33, v33
    v_pk_mul_f32 v[44:45], v[44:45], v[212:213]
    v_pk_mul_f32 v[46:47], v[46:47], v[214:215]
    v_exp_f32 v34, v34
    v_pk_mul_f32 v[40:41], v[40:41], v[216:217]
    v_pk_mul_f32 v[42:43], v[42:43], v[218:219]
    v_exp_f32 v35, v35
    v_pk_mul_f32 v[44:45], v[44:45], v[220:221]
    v_pk_mul_f32 v[46:47], v[46:47], v[222:223]
    v_exp_f32 v36, v36
    v_cvt_pk_bf16_f32 v124, v40, v41
    v_pk_add_f32 v[32:33], v[32:33], 1.0 op_sel_hi:[1,0]
    v_exp_f32 v37, v37
    v_cvt_pk_bf16_f32 v126, v44, v45
    v_pk_add_f32 v[34:35], v[34:35], 1.0 op_sel_hi:[1,0]
    v_exp_f32 v38, v38
    v_cvt_pk_bf16_f32 v125, v42, v43
    v_pk_add_f32 v[36:37], v[36:37], 1.0 op_sel_hi:[1,0]
    v_exp_f32 v39, v39
    v_cvt_pk_bf16_f32 v127, v46, v47
    v_permlane32_swap_b32 v124, v126
    v_pk_add_f32 v[38:39], v[38:39], 1.0 op_sel_hi:[1,0]
    v_permlane32_swap_b32 v125, v127
    buffer_store_dwordx4 v[124:127], v19, s[24:27], s91 offen sc1
    buffer_load_dwordx4 v11, s[20:23], s56 offen offset:2048 lds
    v_rcp_f32 v32, v32
    v_pk_mul_f32 v[40:41], v[240:241], v[240:241]
    v_pk_mul_f32 v[42:43], v[242:243], v[242:243]
    v_rcp_f32 v33, v33
    v_pk_mul_f32 v[44:45], v[244:245], v[244:245]
    v_pk_mul_f32 v[46:47], v[246:247], v[246:247]
    v_rcp_f32 v34, v34
    v_pk_fma_f32 v[40:41], v[40:41], v[20:21], v[22:23]
    v_pk_fma_f32 v[42:43], v[42:43], v[20:21], v[22:23]
    v_rcp_f32 v35, v35
    v_pk_fma_f32 v[44:45], v[44:45], v[20:21], v[22:23]
    v_pk_fma_f32 v[46:47], v[46:47], v[20:21], v[22:23]
    v_rcp_f32 v36, v36
    v_pk_mul_f32 v[40:41], v[40:41], v[240:241]
    v_rcp_f32 v37, v37
    v_pk_mul_f32 v[42:43], v[42:43], v[242:243]
    v_rcp_f32 v38, v38
    v_pk_mul_f32 v[44:45], v[44:45], v[244:245]
    v_rcp_f32 v39, v39
    v_pk_mul_f32 v[46:47], v[46:47], v[246:247]
    ds_read_b64_tr_b16 a[28:29], v106 offset:61440
    v_exp_f32 v40, v40
    v_pk_mul_f32 v[32:33], v[32:33], v[224:225]
    v_pk_mul_f32 v[34:35], v[34:35], v[226:227]
    v_exp_f32 v41, v41
    v_pk_mul_f32 v[36:37], v[36:37], v[228:229]
    v_pk_mul_f32 v[38:39], v[38:39], v[230:231]
    v_exp_f32 v42, v42
    v_pk_mul_f32 v[32:33], v[32:33], v[232:233]
    v_pk_mul_f32 v[34:35], v[34:35], v[234:235]
    v_exp_f32 v43, v43
    v_pk_mul_f32 v[36:37], v[36:37], v[236:237]
    v_pk_mul_f32 v[38:39], v[38:39], v[238:239]
    v_exp_f32 v44, v44
    v_cvt_pk_bf16_f32 v88, v32, v33
    v_pk_add_f32 v[40:41], v[40:41], 1.0 op_sel_hi:[1,0]
    v_exp_f32 v45, v45
    v_cvt_pk_bf16_f32 v90, v36, v37
    v_pk_add_f32 v[42:43], v[42:43], 1.0 op_sel_hi:[1,0]
    v_exp_f32 v46, v46
    v_cvt_pk_bf16_f32 v89, v34, v35
    v_pk_add_f32 v[44:45], v[44:45], 1.0 op_sel_hi:[1,0]
    v_exp_f32 v47, v47
    v_cvt_pk_bf16_f32 v91, v38, v39
    v_permlane32_swap_b32 v88, v90
    v_pk_add_f32 v[46:47], v[46:47], 1.0 op_sel_hi:[1,0]
    v_permlane32_swap_b32 v89, v91
    buffer_store_dwordx4 v[88:91], v19, s[24:27], s92 offen sc1
    ds_read_b64_tr_b16 a[30:31], v106 offset:62464
    buffer_load_dwordx4 v14, s[20:23], s56 offen offset:3072 lds
    v_rcp_f32 v40, v40
    v_rcp_f32 v41, v41
    v_rcp_f32 v42, v42
    v_rcp_f32 v43, v43
    v_rcp_f32 v44, v44
    v_rcp_f32 v45, v45
    v_rcp_f32 v46, v46
    v_rcp_f32 v47, v47
    v_pk_mul_f32 v[40:41], v[40:41], v[240:241]
    v_pk_mul_f32 v[42:43], v[42:43], v[242:243]
    v_pk_mul_f32 v[44:45], v[44:45], v[244:245]
    v_pk_mul_f32 v[46:47], v[46:47], v[246:247]
    v_pk_mul_f32 v[40:41], v[40:41], v[248:249]
    v_pk_mul_f32 v[42:43], v[42:43], v[250:251]
    v_pk_mul_f32 v[44:45], v[44:45], v[252:253]
    v_pk_mul_f32 v[46:47], v[46:47], v[254:255]
    v_cvt_pk_bf16_f32 v92, v40, v41
    v_cvt_pk_bf16_f32 v94, v44, v45
    v_cvt_pk_bf16_f32 v93, v42, v43
    v_cvt_pk_bf16_f32 v95, v46, v47
    v_permlane32_swap_b32 v92, v94
    s_nop 0
    v_permlane32_swap_b32 v93, v95
    buffer_store_dwordx4 v[92:95], v19, s[24:27], s93 offen sc1
    s_waitcnt lgkmcnt(8)
    s_add_u32 m0, s7, 122880
    s_nop 0
LT_hop1:
    s_cbranch_execz LT_back
LW_hop1:
    s_cbranch_execz LW_back
    buffer_load_dwordx4 v9, s[20:23], s6 offen offset:0 lds
    s_waitcnt vmcnt(19)
    ds_read_b64_tr_b16 a[32:33], v100 offset:40960
    ds_read_b64_tr_b16 a[34:35], v100 offset:41984
    ds_read_b64_tr_b16 a[36:37], v101 offset:40960
    buffer_load_dwordx4 v10, s[20:23], s6 offen offset:1024 lds
    ds_read_b64_tr_b16 a[38:39], v101 offset:41984
    ds_read_b64_tr_b16 a[40:41], v102 offset:40960
    ds_read_b64_tr_b16 a[42:43], v102 offset:41984
    s_waitcnt vmcnt(6)
    buffer_store_dwordx2 v[24:25], v133, s[24:27], 0 offen sc1
    buffer_load_dwordx4 v11, s[20:23], s6 offen offset:2048 lds
    ds_read_b64_tr_b16 a[44:45], v103 offset:40960
    ds_read_b64_tr_b16 a[46:47], v103 offset:41984
    ds_read_b64_tr_b16 a[48:49], v100 offset:45056
    buffer_load_dwordx4 v14, s[20:23], s6 offen offset:3072 lds
    ds_read_b64_tr_b16 a[50:51], v100 offset:46080
    ds_read_b64_tr_b16 a[52:53], v101 offset:45056
    ds_read_b64_tr_b16 a[54:55], v101 offset:46080
    s_waitcnt lgkmcnt(12)
    s_add_u32 m0, s7, 126976
    s_add_u32 s6, s6, 40960
    buffer_load_dwordx4 v9, s[20:23], s6 offen offset:0 lds
    ds_read_b64_tr_b16 a[56:57], v102 offset:45056
    ds_read_b64_tr_b16 a[58:59], v102 offset:46080
    ds_read_b64_tr_b16 a[60:61], v103 offset:45056
    buffer_load_dwordx4 v10, s[20:23], s6 offen offset:1024 lds
    ds_read_b64_tr_b16 a[62:63], v103 offset:46080
    ds_read_b64_tr_b16 a[64:65], v99 offset:16384
    ds_read_b64_tr_b16 a[66:67], v99 offset:17408
    buffer_load_dwordx4 v11, s[20:23], s6 offen offset:2048 lds
    ds_read_b64_tr_b16 a[68:69], v104 offset:16384
    ds_read_b64_tr_b16 a[70:71], v104 offset:17408
    ds_read_b64_tr_b16 a[72:73], v105 offset:16384
    buffer_load_dwordx4 v14, s[20:23], s6 offen offset:3072 lds
    ds_read_b64_tr_b16 a[74:75], v105 offset:17408
    ds_read_b64_tr_b16 a[76:77], v106 offset:16384
    ds_read_b64_tr_b16 a[78:79], v106 offset:17408
    s_waitcnt vmcnt(9)
    buffer_store_dwordx2 v[24:25], v134, s[24:27], 0 offen sc1
    s_waitcnt lgkmcnt(15)
    s_add_u32 m0, s7, 40960
    s_add_u32 s6, s6, 40960
    buffer_load_dwordx4 v9, s[20:23], s6 offen offset:0 lds
    ds_read_b64_tr_b16 a[80:81], v99 offset:20480
    ds_read_b64_tr_b16 a[82:83], v99 offset:21504
    ds_read_b64_tr_b16 a[84:85], v104 offset:20480
    buffer_load_dwordx4 v10, s[20:23], s6 offen offset:1024 lds
    ds_read_b64_tr_b16 a[86:87], v104 offset:21504
    ds_read_b64_tr_b16 a[88:89], v105 offset:20480
    ds_read_b64_tr_b16 a[90:91], v105 offset:21504
    buffer_load_dwordx4 v11, s[20:23], s6 offen offset:2048 lds
    ds_read_b64_tr_b16 a[92:93], v106 offset:20480
    ds_read_b64_tr_b16 a[94:95], v106 offset:21504
    buffer_load_dwordx4 v14, s[20:23], s6 offen offset:3072 lds
    s_waitcnt lgkmcnt(15)
    s_add_u32 m0, s7, 45056
    s_add_u32 s6, s6, 40960
    buffer_load_dwordx4 v9, s[20:23], s6 offen offset:0 lds
    buffer_load_dwordx4 v10, s[20:23], s6 offen offset:1024 lds
    s_waitcnt vmcnt(11)
    ds_read_b64_tr_b16 a[96:97], v99 offset:57344
    ds_read_b64_tr_b16 a[98:99], v99 offset:58368
    ds_read_b64_tr_b16 a[100:101], v104 offset:57344
    buffer_load_dwordx4 v11, s[20:23], s6 offen offset:2048 lds
    ds_read_b64_tr_b16 a[102:103], v104 offset:58368
    ds_read_b64_tr_b16 a[104:105], v105 offset:57344
    ds_read_b64_tr_b16 a[106:107], v105 offset:58368
    buffer_load_dwordx4 v14, s[20:23], s6 offen offset:3072 lds
    ds_read_b64_tr_b16 a[108:109], v106 offset:57344
    ds_read_b64_tr_b16 a[110:111], v106 offset:58368
    s_waitcnt lgkmcnt(15)
    s_add_u32 m0, s7, 81920
    s_add_u32 s6, s6, 40960
    buffer_load_dwordx4 v9, s[20:23], s6 offen offset:0 lds
    buffer_load_dwordx4 v10, s[20:23], s6 offen offset:1024 lds
    s_waitcnt vmcnt(11)
    ds_read_b64_tr_b16 a[112:113], v99 offset:61440
    ds_read_b64_tr_b16 a[114:115], v99 offset:62464
    ds_read_b64_tr_b16 a[116:117], v104 offset:61440
    buffer_load_dwordx2 v[26:27], v28, s[24:27], 0 offen sc1
    buffer_load_dwordx4 v11, s[20:23], s6 offen offset:2048 lds
    ds_read_b64_tr_b16 a[118:119], v104 offset:62464
    ds_read_b64_tr_b16 a[120:121], v105 offset:61440
    ds_read_b64_tr_b16 a[122:123], v105 offset:62464
    buffer_load_dwordx4 v14, s[20:23], s6 offen offset:3072 lds
    ds_read_b64_tr_b16 a[124:125], v106 offset:61440
    ds_read_b64_tr_b16 a[126:127], v106 offset:62464
    s_waitcnt lgkmcnt(15)
    s_add_u32 m0, s7, 86016
    s_add_u32 s6, s6, 40960
    buffer_load_dwordx4 v9, s[20:23], s6 offen offset:0 lds
    buffer_load_dwordx4 v10, s[20:23], s6 offen offset:1024 lds
    s_waitcnt vmcnt(11)
    ds_read_b64_tr_b16 a[128:129], v100 offset:40960
    ds_read_b64_tr_b16 a[130:131], v100 offset:41984
    ds_read_b64_tr_b16 a[132:133], v101 offset:40960
    s_cmp_eq_u32 s83, 0
    s_cbranch_scc1 L_fin
    buffer_load_dwordx4 v11, s[20:23], s6 offen offset:2048 lds
    ds_read_b64_tr_b16 a[134:135], v101 offset:41984
    ds_read_b64_tr_b16 a[136:137], v102 offset:40960
    ds_read_b64_tr_b16 a[138:139], v102 offset:41984
    buffer_load_dwordx4 v14, s[20:23], s6 offen offset:3072 lds
    ds_read_b64_tr_b16 a[140:141], v103 offset:40960
    ds_read_b64_tr_b16 a[142:143], v103 offset:41984
    s_waitcnt vmcnt(6)
    ds_read_b64_tr_b16 a[144:145], v100 offset:45056
    ds_read_b64_tr_b16 a[146:147], v100 offset:46080
    ds_read_b64_tr_b16 a[148:149], v101 offset:45056
    ds_read_b64_tr_b16 a[150:151], v101 offset:46080
    ds_read_b64_tr_b16 a[152:153], v102 offset:45056
    ds_read_b64_tr_b16 a[154:155], v102 offset:46080
    ds_read_b64_tr_b16 a[156:157], v103 offset:45056
    ds_read_b64_tr_b16 a[158:159], v103 offset:46080
    s_waitcnt vmcnt(4)
    ds_read_b64_tr_b16 a[160:161], v99 offset:16384
    ds_read_b64_tr_b16 a[162:163], v99 offset:17408
    ds_read_b64_tr_b16 a[164:165], v104 offset:16384
    ds_read_b64_tr_b16 a[166:167], v104 offset:17408
    ds_read_b64_tr_b16 a[168:169], v105 offset:16384
    ds_read_b64_tr_b16 a[170:171], v105 offset:17408
    ds_read_b64_tr_b16 a[172:173], v106 offset:16384
    ds_read_b64_tr_b16 a[174:175], v106 offset:17408
    v_cmp_ne_u64 vcc, v[24:25], v[26:27]
    s_nop 1
    s_mov_b32 s94, 100000
    s_cbranch_vccz L_hf_ok
L_hf_spin:
    buffer_load_dwordx2 v[26:27], v28, s[24:27], 0 offen sc1
    s_waitcnt vmcnt(0)
    v_cmp_ne_u64 vcc, v[24:25], v[26:27]
    s_nop 1
    s_sub_u32 s94, s94, 1
    s_cbranch_vccz L_hf_ok
    s_cmp_lg_u32 s94, 0
    s_cbranch_scc1 L_hf_spin
L_hf_ok:
    s_mul_i32 s62, s76, 49152
    s_add_u32 s97, s62, s53
    buffer_load_dwordx4 v[160:163], v130, s[24:27], s97 offen offset:0 sc1
    buffer_load_dwordx4 v[164:167], v130, s[24:27], s97 offen offset:1024 sc1
    buffer_load_dwordx4 v[168:171], v130, s[24:27], s97 offen offset:2048 sc1
    buffer_load_dwordx4 v[172:175], v130, s[24:27], s97 offen offset:3072 sc1
    s_add_u32 s97, s97, 4096
    buffer_load_dwordx4 v[176:179], v130, s[24:27], s97 offen offset:0 sc1
    buffer_load_dwordx4 v[180:183], v130, s[24:27], s97 offen offset:1024 sc1
    s_add_u32 s97, s62, s96
    buffer_load_dwordx4 v[184:187], v130, s[24:27], s97 offen offset:0 sc1
    buffer_load_dwordx4 v[188:191], v130, s[24:27], s97 offen offset:1024 sc1
    buffer_load_dwordx4 v[192:195], v130, s[24:27], s97 offen offset:2048 sc1
    buffer_load_dwordx4 v[196:199], v130, s[24:27], s97 offen offset:3072 sc1
    s_add_u32 s97, s97, 4096
    buffer_load_dwordx4 v[200:203], v130, s[24:27], s97 offen offset:0 sc1
    s_waitcnt vmcnt(10)
    v_mfma_f32_16x16x32_bf16 v[32:35], a[0:3], v[160:163], 0
    buffer_load_dwordx4 v[204:207], v130, s[24:27], s97 offen offset:1024 sc1
    v_mfma_f32_16x16x32_bf16 v[36:39], a[4:7], v[160:163], 0
    ds_read_b64_tr_b16 a[176:177], v99 offset:20480
    v_mfma_f32_16x16x32_bf16 v[40:43], a[8:11], v[160:163], 0
    ds_read_b64_tr_b16 a[178:179], v99 offset:21504
    v_mfma_f32_16x16x32_bf16 v[44:47], a[12:15], v[160:163], 0
    ds_read_b64_tr_b16 a[180:181], v104 offset:20480
    s_waitcnt vmcnt(10)
    v_mfma_f32_16x16x32_bf16 v[32:35], a[16:19], v[164:167], v[32:35]
    s_mul_i32 s62, s77, 49152
    s_add_u32 s97, s62, s53
    buffer_load_dwordx4 v[160:163], v130, s[24:27], s97 offen offset:0 sc1
    v_mfma_f32_16x16x32_bf16 v[36:39], a[20:23], v[164:167], v[36:39]
    ds_read_b64_tr_b16 a[182:183], v104 offset:21504
    v_mfma_f32_16x16x32_bf16 v[40:43], a[24:27], v[164:167], v[40:43]
    ds_read_b64_tr_b16 a[184:185], v105 offset:20480
    buffer_load_dwordx2 v[26:27], v29, s[24:27], 0 offen sc1
    v_mfma_f32_16x16x32_bf16 v[44:47], a[28:31], v[164:167], v[44:47]
    ds_read_b64_tr_b16 a[186:187], v105 offset:21504
    s_waitcnt vmcnt(11)
    v_mfma_f32_16x16x32_bf16 v[32:35], a[32:35], v[168:171], v[32:35]
    buffer_load_dwordx4 v[164:167], v130, s[24:27], s97 offen offset:1024 sc1
    v_mfma_f32_16x16x32_bf16 v[36:39], a[36:39], v[168:171], v[36:39]
    ds_read_b64_tr_b16 a[188:189], v106 offset:20480
    v_mfma_f32_16x16x32_bf16 v[40:43], a[40:43], v[168:171], v[40:43]
    ds_read_b64_tr_b16 a[190:191], v106 offset:21504
    v_mfma_f32_16x16x32_bf16 v[44:47], a[44:47], v[168:171], v[44:47]
    s_waitcnt vmcnt(11)
    v_mfma_f32_16x16x32_bf16 v[32:35], a[48:51], v[172:175], v[32:35]
    buffer_load_dwordx4 v[168:171], v130, s[24:27], s97 offen offset:2048 sc1
    v_mfma_f32_16x16x32_bf16 v[36:39], a[52:55], v[172:175], v[36:39]
    v_mfma_f32_16x16x32_bf16 v[40:43], a[56:59], v[172:175], v[40:43]
    v_mfma_f32_16x16x32_bf16 v[44:47], a[60:63], v[172:175], v[44:47]
    s_waitcnt vmcnt(11)
    v_mfma_f32_16x16x32_bf16 v[32:35], a[64:67], v[176:179], v[32:35]
    buffer_load_dwordx4 v[172:175], v130, s[24:27], s97 offen offset:3072 sc1
    v_mfma_f32_16x16x32_bf16 v[36:39], a[68:71], v[176:179], v[36:39]
    v_mfma_f32_16x16x32_bf16 v[40:43], a[72:75], v[176:179], v[40:43]
    v_mfma_f32_16x16x32_bf16 v[44:47], a[76:79], v[176:179], v[44:47]
    s_waitcnt vmcnt(11)
    v_mfma_f32_16x16x32_bf16 v[32:35], a[80:83], v[180:183], v[32:35]
    s_add_u32 s97, s97, 4096
    buffer_load_dwordx4 v[176:179], v130, s[24:27], s97 offen offset:0 sc1
    v_mfma_f32_16x16x32_bf16 v[36:39], a[84:87], v[180:183], v[36:39]
    v_mfma_f32_16x16x32_bf16 v[40:43], a[88:91], v[180:183], v[40:43]
    v_mfma_f32_16x16x32_bf16 v[44:47], a[92:95], v[180:183], v[44:47]
    s_waitcnt vmcnt(11) lgkmcnt(15)
    v_mfma_f32_16x16x32_bf16 v[32:35], a[96:99], v[184:187], v[32:35]
    buffer_load_dwordx4 v[180:183], v130, s[24:27], s97 offen offset:1024 sc1
    v_mfma_f32_16x16x32_bf16 v[36:39], a[100:103], v[184:187], v[36:39]
    v_mfma_f32_16x16x32_bf16 v[40:43], a[104:107], v[184:187], v[40:43]
    v_mfma_f32_16x16x32_bf16 v[44:47], a[108:111], v[184:187], v[44:47]
    s_waitcnt vmcnt(11)
    v_mfma_f32_16x16x32_bf16 v[32:35], a[112:115], v[188:191], v[32:35]
    s_add_u32 s97, s62, s96
    buffer_load_dwordx4 v[184:187], v130, s[24:27], s97 offen offset:0 sc1
    v_mfma_f32_16x16x32_bf16 v[36:39], a[116:119], v[188:191], v[36:39]
    v_mfma_f32_16x16x32_bf16 v[40:43], a[120:123], v[188:191], v[40:43]
    v_mfma_f32_16x16x32_bf16 v[44:47], a[124:127], v[188:191], v[44:47]
    s_waitcnt vmcnt(11)
    v_mfma_f32_16x16x32_bf16 v[32:35], a[128:131], v[192:195], v[32:35]
    buffer_load_dwordx4 v[188:191], v130, s[24:27], s97 offen offset:1024 sc1
    v_mfma_f32_16x16x32_bf16 v[36:39], a[132:135], v[192:195], v[36:39]
    v_mfma_f32_16x16x32_bf16 v[40:43], a[136:139], v[192:195], v[40:43]
    v_mfma_f32_16x16x32_bf16 v[44:47], a[140:143], v[192:195], v[44:47]
    s_waitcnt vmcnt(11)
    v_mfma_f32_16x16x32_bf16 v[32:35], a[144:147], v[196:199], v[32:35]
    buffer_load_dwordx4 v[192:195], v130, s[24:27], s97 offen offset:2048 sc1
    v_mfma_f32_16x16x32_bf16 v[36:39], a[148:151], v[196:199], v[36:39]
    v_mfma_f32_16x16x32_bf16 v[40:43], a[152:155], v[196:199], v[40:43]
    v_mfma_f32_16x16x32_bf16 v[44:47], a[156:159], v[196:199], v[44:47]
    s_waitcnt vmcnt(11) lgkmcnt(14)
    v_mfma_f32_16x16x32_bf16 v[32:35], a[160:163], v[200:203], v[32:35]
    buffer_load_dwordx4 v[196:199], v130, s[24:27], s97 offen offset:3072 sc1
    s_waitcnt lgkmcnt(12)
    v_mfma_f32_16x16x32_bf16 v[36:39], a[164:167], v[200:203], v[36:39]
    s_waitcnt lgkmcnt(10)
    v_mfma_f32_16x16x32_bf16 v[40:43], a[168:171], v[200:203], v[40:43]
    s_waitcnt lgkmcnt(8)
    v_mfma_f32_16x16x32_bf16 v[44:47], a[172:175], v[200:203], v[44:47]
    s_waitcnt vmcnt(11) lgkmcnt(6)
    v_mfma_f32_16x16x32_bf16 v[32:35], a[176:179], v[204:207], v[32:35]
    s_add_u32 s97, s97, 4096
    buffer_load_dwordx4 v[200:203], v130, s[24:27], s97 offen offset:0 sc1
    s_waitcnt lgkmcnt(4)
    v_mfma_f32_16x16x32_bf16 v[36:39], a[180:183], v[204:207], v[36:39]
    s_waitcnt lgkmcnt(2)
    v_mfma_f32_16x16x32_bf16 v[40:43], a[184:187], v[204:207], v[40:43]
    s_waitcnt lgkmcnt(0)
    v_mfma_f32_16x16x32_bf16 v[44:47], a[188:191], v[204:207], v[44:47]
    s_waitcnt vmcnt(11)
    v_mfma_f32_16x16x32_bf16 v[48:51], a[0:3], v[160:163], 0
    buffer_load_dwordx4 v[204:207], v130, s[24:27], s97 offen offset:1024 sc1
    v_mfma_f32_16x16x32_bf16 v[52:55], a[4:7], v[160:163], 0
    v_mfma_f32_16x16x32_bf16 v[56:59], a[8:11], v[160:163], 0
    v_mfma_f32_16x16x32_bf16 v[60:63], a[12:15], v[160:163], 0
    s_waitcnt vmcnt(11)
    v_cmp_ne_u64 vcc, v[24:25], v[26:27]
    s_nop 1
    s_and_b64 s[58:59], vcc, s[70:71]
    s_cbranch_scc1 L_again1
L_ok1:
    s_waitcnt vmcnt(10)
    v_mfma_f32_16x16x32_bf16 v[48:51], a[16:19], v[164:167], v[48:51]
    s_mul_i32 s62, s78, 49152
    s_add_u32 s97, s62, s53
    buffer_load_dwordx4 v[160:163], v130, s[24:27], s97 offen offset:0 sc1
    v_mfma_f32_16x16x32_bf16 v[52:55], a[20:23], v[164:167], v[52:55]
    ds_write_b128 v96, v[32:35] offset:0
    v_mfma_f32_16x16x32_bf16 v[56:59], a[24:27], v[164:167], v[56:59]
    v_mfma_f32_16x16x32_bf16 v[60:63], a[28:31], v[164:167], v[60:63]
    ds_write_b128 v96, v[36:39] offset:64
    s_waitcnt vmcnt(10)
    v_mfma_f32_16x16x32_bf16 v[48:51], a[32:35], v[168:171], v[48:51]
    buffer_load_dwordx4 v[164:167], v130, s[24:27], s97 offen offset:1024 sc1
    v_mfma_f32_16x16x32_bf16 v[52:55], a[36:39], v[168:171], v[52:55]
    v_mfma_f32_16x16x32_bf16 v[56:59], a[40:43], v[168:171], v[56:59]
    ds_write_b128 v96, v[40:43] offset:128
    v_mfma_f32_16x16x32_bf16 v[60:63], a[44:47], v[168:171], v[60:63]
    s_waitcnt vmcnt(10)
    v_mfma_f32_16x16x32_bf16 v[48:51], a[48:51], v[172:175], v[48:51]
    buffer_load_dwordx4 v[168:171], v130, s[24:27], s97 offen offset:2048 sc1
    v_mfma_f32_16x16x32_bf16 v[52:55], a[52:55], v[172:175], v[52:55]
    ds_write_b128 v96, v[44:47] offset:192
    v_mfma_f32_16x16x32_bf16 v[56:59], a[56:59], v[172:175], v[56:59]
    v_mfma_f32_16x16x32_bf16 v[60:63], a[60:63], v[172:175], v[60:63]
    s_waitcnt vmcnt(10)
    v_mfma_f32_16x16x32_bf16 v[48:51], a[64:67], v[176:179], v[48:51]
    buffer_load_dwordx4 v[172:175], v130, s[24:27], s97 offen offset:3072 sc1
    v_mfma_f32_16x16x32_bf16 v[52:55], a[68:71], v[176:179], v[52:55]
    s_waitcnt lgkmcnt(0)
    s_barrier
    v_mfma_f32_16x16x32_bf16 v[56:59], a[72:75], v[176:179], v[56:59]
    ds_read_b128 v[208:211], v97 offset:0
    v_mfma_f32_16x16x32_bf16 v[60:63], a[76:79], v[176:179], v[60:63]
    ds_read_b128 v[212:215], v97 offset:10240
    s_waitcnt vmcnt(10)
    v_mfma_f32_16x16x32_bf16 v[48:51], a[80:83], v[180:183], v[48:51]
    s_add_u32 s97, s97, 4096
    buffer_load_dwordx4 v[176:179], v130, s[24:27], s97 offen offset:0 sc1
    v_mfma_f32_16x16x32_bf16 v[52:55], a[84:87], v[180:183], v[52:55]
    ds_read_b128 v[216:219], v97 offset:20480
    v_mfma_f32_16x16x32_bf16 v[56:59], a[88:91], v[180:183], v[56:59]
    ds_read_b128 v[220:223], v97 offset:30720
    v_mfma_f32_16x16x32_bf16 v[60:63], a[92:95], v[180:183], v[60:63]
    s_waitcnt vmcnt(10)
    v_mfma_f32_16x16x32_bf16 v[48:51], a[96:99], v[184:187], v[48:51]
    buffer_load_dwordx4 v[180:183], v130, s[24:27], s97 offen offset:1024 sc1
    v_mfma_f32_16x16x32_bf16 v[52:55], a[100:103], v[184:187], v[52:55]
    v_mfma_f32_16x16x32_bf16 v[56:59], a[104:107], v[184:187], v[56:59]
    v_mfma_f32_16x16x32_bf16 v[60:63], a[108:111], v[184:187], v[60:63]
    s_waitcnt lgkmcnt(0)
    v_add_f32 v208, v208, v212
    s_waitcnt vmcnt(10)
    v_mfma_f32_16x16x32_bf16 v[48:51], a[112:115], v[188:191], v[48:51]
    s_add_u32 s97, s62, s96
    buffer_load_dwordx4 v[184:187], v130, s[24:27], s97 offen offset:0 sc1
    v_mfma_f32_16x16x32_bf16 v[52:55], a[116:119], v[188:191], v[52:55]
    v_add_f32 v209, v209, v213
    v_mfma_f32_16x16x32_bf16 v[56:59], a[120:123], v[188:191], v[56:59]
    v_add_f32 v210, v210, v214
    v_mfma_f32_16x16x32_bf16 v[60:63], a[124:127], v[188:191], v[60:63]
    v_add_f32 v211, v211, v215
    s_waitcnt vmcnt(10)
    v_mfma_f32_16x16x32_bf16 v[48:51], a[128:131], v[192:195], v[48:51]
    buffer_load_dwordx4 v[188:191], v130, s[24:27], s97 offen offset:1024 sc1
    v_mfma_f32_16x16x32_bf16 v[52:55], a[132:135], v[192:195], v[52:55]
    v_add_f32 v216, v216, v220
    v_mfma_f32_16x16x32_bf16 v[56:59], a[136:139], v[192:195], v[56:59]
    v_add_f32 v217, v217, v221
    v_mfma_f32_16x16x32_bf16 v[60:63], a[140:143], v[192:195], v[60:63]
    v_add_f32 v218, v218, v222
    s_waitcnt vmcnt(10)
    v_mfma_f32_16x16x32_bf16 v[48:51], a[144:147], v[196:199], v[48:51]
    buffer_load_dwordx4 v[192:195], v130, s[24:27], s97 offen offset:2048 sc1
    v_mfma_f32_16x16x32_bf16 v[52:55], a[148:151], v[196:199], v[52:55]
    v_add_f32 v219, v219, v223
    v_mfma_f32_16x16x32_bf16 v[56:59], a[152:155], v[196:199], v[56:59]
    v_add_f32 v208, v208, v216
    v_mfma_f32_16x16x32_bf16 v[60:63], a[156:159], v[196:199], v[60:63]
    v_add_f32 v209, v209, v217
    s_waitcnt vmcnt(10)
    v_mfma_f32_16x16x32_bf16 v[48:51], a[160:163], v[200:203], v[48:51]
    buffer_load_dwordx4 v[196:199], v130, s[24:27], s97 offen offset:3072 sc1
    v_mfma_f32_16x16x32_bf16 v[52:55], a[164:167], v[200:203], v[52:55]
    v_add_f32 v210, v210, v218
    v_mfma_f32_16x16x32_bf16 v[56:59], a[168:171], v[200:203], v[56:59]
    v_add_f32 v211, v211, v219
    v_mfma_f32_16x16x32_bf16 v[60:63], a[172:175], v[200:203], v[60:63]
    v_cvt_pk_bf16_f32 v240, v208, v209
    s_waitcnt vmcnt(10)
    v_mfma_f32_16x16x32_bf16 v[48:51], a[176:179], v[204:207], v[48:51]
    s_add_u32 s97, s97, 4096
    buffer_load_dwordx4 v[200:203], v130, s[24:27], s97 offen offset:0 sc1
    v_mfma_f32_16x16x32_bf16 v[52:55], a[180:183], v[204:207], v[52:55]
    v_cvt_pk_bf16_f32 v241, v210, v211
    v_mfma_f32_16x16x32_bf16 v[56:59], a[184:187], v[204:207], v[56:59]
    v_mfma_f32_16x16x32_bf16 v[60:63], a[188:191], v[204:207], v[60:63]
    s_waitcnt vmcnt(10)
    v_mfma_f32_16x16x32_bf16 v[32:35], a[0:3], v[160:163], 0
    buffer_load_dwordx4 v[204:207], v130, s[24:27], s97 offen offset:1024 sc1
    v_mfma_f32_16x16x32_bf16 v[36:39], a[4:7], v[160:163], 0
    v_mfma_f32_16x16x32_bf16 v[40:43], a[8:11], v[160:163], 0
    v_mfma_f32_16x16x32_bf16 v[44:47], a[12:15], v[160:163], 0
    s_and_b64 s[58:59], vcc, s[72:73]
    s_cbranch_scc1 L_again2
L_ok2:
    s_waitcnt vmcnt(10)
    v_mfma_f32_16x16x32_bf16 v[32:35], a[16:19], v[164:167], v[32:35]
    s_mul_i32 s62, s79, 49152
    s_add_u32 s97, s62, s53
    buffer_load_dwordx4 v[160:163], v130, s[24:27], s97 offen offset:0 sc1
    v_mfma_f32_16x16x32_bf16 v[36:39], a[20:23], v[164:167], v[36:39]
    ds_write_b128 v96, v[48:51] offset:4352
    v_mfma_f32_16x16x32_bf16 v[40:43], a[24:27], v[164:167], v[40:43]
    v_mfma_f32_16x16x32_bf16 v[44:47], a[28:31], v[164:167], v[44:47]
    ds_write_b128 v96, v[52:55] offset:4416
    s_waitcnt vmcnt(10)
    v_mfma_f32_16x16x32_bf16 v[32:35], a[32:35], v[168:171], v[32:35]
    buffer_load_dwordx4 v[164:167], v130, s[24:27], s97 offen offset:1024 sc1
    v_mfma_f32_16x16x32_bf16 v[36:39], a[36:39], v[168:171], v[36:39]
    v_mfma_f32_16x16x32_bf16 v[40:43], a[40:43], v[168:171], v[40:43]
    ds_write_b128 v96, v[56:59] offset:4480
    v_mfma_f32_16x16x32_bf16 v[44:47], a[44:47], v[168:171], v[44:47]
    s_waitcnt vmcnt(10)
    v_mfma_f32_16x16x32_bf16 v[32:35], a[48:51], v[172:175], v[32:35]
    buffer_load_dwordx4 v[168:171], v130, s[24:27], s97 offen offset:2048 sc1
    v_mfma_f32_16x16x32_bf16 v[36:39], a[52:55], v[172:175], v[36:39]
    ds_write_b128 v96, v[60:63] offset:4544
    v_mfma_f32_16x16x32_bf16 v[40:43], a[56:59], v[172:175], v[40:43]
    v_mfma_f32_16x16x32_bf16 v[44:47], a[60:63], v[172:175], v[44:47]
    s_waitcnt vmcnt(10)
    v_mfma_f32_16x16x32_bf16 v[32:35], a[64:67], v[176:179], v[32:35]
    buffer_load_dwordx4 v[172:175], v130, s[24:27], s97 offen offset:3072 sc1
    v_mfma_f32_16x16x32_bf16 v[36:39], a[68:71], v[176:179], v[36:39]
    s_waitcnt lgkmcnt(0)
    s_barrier
    v_mfma_f32_16x16x32_bf16 v[40:43], a[72:75], v[176:179], v[40:43]
    ds_read_b128 v[208:211], v97 offset:4352
    v_mfma_f32_16x16x32_bf16 v[44:47], a[76:79], v[176:179], v[44:47]
    ds_read_b128 v[212:215], v97 offset:14592
    s_waitcnt vmcnt(10)
    v_mfma_f32_16x16x32_bf16 v[32:35], a[80:83], v[180:183], v[32:35]
    s_add_u32 s97, s97, 4096
    buffer_load_dwordx4 v[176:179], v130, s[24:27], s97 offen offset:0 sc1
    v_mfma_f32_16x16x32_bf16 v[36:39], a[84:87], v[180:183], v[36:39]
    ds_read_b128 v[216:219], v97 offset:24832
    v_mfma_f32_16x16x32_bf16 v[40:43], a[88:91], v[180:183], v[40:43]
    ds_read_b128 v[220:223], v97 offset:35072
    v_mfma_f32_16x16x32_bf16 v[44:47], a[92:95], v[180:183], v[44:47]
    s_waitcnt vmcnt(10)
    v_mfma_f32_16x16x32_bf16 v[32:35], a[96:99], v[184:187], v[32:35]
    buffer_load_dwordx4 v[180:183], v130, s[24:27], s97 offen offset:1024 sc1
    v_mfma_f32_16x16x32_bf16 v[36:39], a[100:103], v[184:187], v[36:39]
    v_mfma_f32_16x16x32_bf16 v[40:43], a[104:107], v[184:187], v[40:43]
    v_mfma_f32_16x16x32_bf16 v[44:47], a[108:111], v[184:187], v[44:47]
    s_waitcnt lgkmcnt(0)
    v_add_f32 v208, v208, v212
    s_waitcnt vmcnt(10)
    v_mfma_f32_16x16x32_bf16 v[32:35], a[112:115], v[188:191], v[32:35]
    s_add_u32 s97, s62, s96
    buffer_load_dwordx4 v[184:187], v130, s[24:27], s97 offen offset:0 sc1
    v_mfma_f32_16x16x32_bf16 v[36:39], a[116:119], v[188:191], v[36:39]
    v_add_f32 v209, v209, v213
    v_mfma_f32_16x16x32_bf16 v[40:43], a[120:123], v[188:191], v[40:43]
    v_add_f32 v210, v210, v214
    v_mfma_f32_16x16x32_bf16 v[44:47], a[124:127], v[188:191], v[44:47]
    v_add_f32 v211, v211, v215
    s_waitcnt vmcnt(10)
    v_mfma_f32_16x16x32_bf16 v[32:35], a[128:131], v[192:195], v[32:35]
    buffer_load_dwordx4 v[188:191], v130, s[24:27], s97 offen offset:1024 sc1
    v_mfma_f32_16x16x32_bf16 v[36:39], a[132:135], v[192:195], v[36:39]
    v_add_f32 v216, v216, v220
    v_mfma_f32_16x16x32_bf16 v[40:43], a[136:139], v[192:195], v[40:43]
    v_add_f32 v217, v217, v221
    v_mfma_f32_16x16x32_bf16 v[44:47], a[140:143], v[192:195], v[44:47]
    v_add_f32 v218, v218, v222
    s_waitcnt vmcnt(10)
    v_mfma_f32_16x16x32_bf16 v[32:35], a[144:147], v[196:199], v[32:35]
    buffer_load_dwordx4 v[192:195], v130, s[24:27], s97 offen offset:2048 sc1
    v_mfma_f32_16x16x32_bf16 v[36:39], a[148:151], v[196:199], v[36:39]
    v_add_f32 v219, v219, v223
    v_mfma_f32_16x16x32_bf16 v[40:43], a[152:155], v[196:199], v[40:43]
    v_add_f32 v208, v208, v216
    v_mfma_f32_16x16x32_bf16 v[44:47], a[156:159], v[196:199], v[44:47]
    v_add_f32 v209, v209, v217
    s_waitcnt vmcnt(10)
    v_mfma_f32_16x16x32_bf16 v[32:35], a[160:163], v[200:203], v[32:35]
    buffer_load_dwordx4 v[196:199], v130, s[24:27], s97 offen offset:3072 sc1
    v_mfma_f32_16x16x32_bf16 v[36:39], a[164:167], v[200:203], v[36:39]
    v_add_f32 v210, v210, v218
    v_mfma_f32_16x16x32_bf16 v[40:43], a[168:171], v[200:203], v[40:43]
    v_add_f32 v211, v211, v219
    v_mfma_f32_16x16x32_bf16 v[44:47], a[172:175], v[200:203], v[44:47]
    v_cvt_pk_bf16_f32 v242, v208, v209
    s_waitcnt vmcnt(10)
    v_mfma_f32_16x16x32_bf16 v[32:35], a[176:179], v[204:207], v[32:35]
    s_add_u32 s97, s97, 4096
    buffer_load_dwordx4 v[200:203], v130, s[24:27], s97 offen offset:0 sc1
    v_mfma_f32_16x16x32_bf16 v[36:39], a[180:183], v[204:207], v[36:39]
    v_cvt_pk_bf16_f32 v243, v210, v211
    v_mfma_f32_16x16x32_bf16 v[40:43], a[184:187], v[204:207], v[40:43]
    v_mfma_f32_16x16x32_bf16 v[44:47], a[188:191], v[204:207], v[44:47]
    s_waitcnt vmcnt(10)
    v_mfma_f32_16x16x32_bf16 v[48:51], a[0:3], v[160:163], 0
    buffer_load_dwordx4 v[204:207], v130, s[24:27], s97 offen offset:1024 sc1
    v_mfma_f32_16x16x32_bf16 v[52:55], a[4:7], v[160:163], 0
    v_mfma_f32_16x16x32_bf16 v[56:59], a[8:11], v[160:163], 0
    v_mfma_f32_16x16x32_bf16 v[60:63], a[12:15], v[160:163], 0
    s_and_b64 s[58:59], vcc, s[74:75]
    s_cbranch_scc1 L_again3
L_ok3:
    s_waitcnt vmcnt(10)
    v_mfma_f32_16x16x32_bf16 v[48:51], a[16:19], v[164:167], v[48:51]
    s_mul_i32 s62, s80, 49152
    s_add_u32 s97, s62, s53
    buffer_load_dwordx4 v[160:163], v130, s[24:27], s97 offen offset:0 sc1
    v_mfma_f32_16x16x32_bf16 v[52:55], a[20:23], v[164:167], v[52:55]
    ds_write_b128 v96, v[32:35] offset:0
    v_mfma_f32_16x16x32_bf16 v[56:59], a[24:27], v[164:167], v[56:59]
    v_mfma_f32_16x16x32_bf16 v[60:63], a[28:31], v[164:167], v[60:63]
    ds_write_b128 v96, v[36:39] offset:64
    s_waitcnt vmcnt(10)
    v_mfma_f32_16x16x32_bf16 v[48:51], a[32:35], v[168:171], v[48:51]
    buffer_load_dwordx4 v[164:167], v130, s[24:27], s97 offen offset:1024 sc1
    v_mfma_f32_16x16x32_bf16 v[52:55], a[36:39], v[168:171], v[52:55]
    v_mfma_f32_16x16x32_bf16 v[56:59], a[40:43], v[168:171], v[56:59]
    ds_write_b128 v96, v[40:43] offset:128
    v_mfma_f32_16x16x32_bf16 v[60:63], a[44:47], v[168:171], v[60:63]
    s_waitcnt vmcnt(10)
    v_mfma_f32_16x16x32_bf16 v[48:51], a[48:51], v[172:175], v[48:51]
    buffer_load_dwordx4 v[168:171], v130, s[24:27], s97 offen offset:2048 sc1
    v_mfma_f32_16x16x32_bf16 v[52:55], a[52:55], v[172:175], v[52:55]
    ds_write_b128 v96, v[44:47] offset:192
    v_mfma_f32_16x16x32_bf16 v[56:59], a[56:59], v[172:175], v[56:59]
    v_mfma_f32_16x16x32_bf16 v[60:63], a[60:63], v[172:175], v[60:63]
    s_waitcnt vmcnt(10)
    v_mfma_f32_16x16x32_bf16 v[48:51], a[64:67], v[176:179], v[48:51]
    buffer_load_dwordx4 v[172:175], v130, s[24:27], s97 offen offset:3072 sc1
    v_mfma_f32_16x16x32_bf16 v[52:55], a[68:71], v[176:179], v[52:55]
    s_waitcnt lgkmcnt(0)
    s_barrier
    v_mfma_f32_16x16x32_bf16 v[56:59], a[72:75], v[176:179], v[56:59]
    ds_read_b128 v[208:211], v97 offset:0
    v_mfma_f32_16x16x32_bf16 v[60:63], a[76:79], v[176:179], v[60:63]
    ds_read_b128 v[212:215], v97 offset:10240
    s_waitcnt vmcnt(10)
    v_mfma_f32_16x16x32_bf16 v[48:51], a[80:83], v[180:183], v[48:51]
    s_add_u32 s97, s97, 4096
    buffer_load_dwordx4 v[176:179], v130, s[24:27], s97 offen offset:0 sc1
    v_mfma_f32_16x16x32_bf16 v[52:55], a[84:87], v[180:183], v[52:55]
    ds_read_b128 v[216:219], v97 offset:20480
    v_mfma_f32_16x16x32_bf16 v[56:59], a[88:91], v[180:183], v[56:59]
    ds_read_b128 v[220:223], v97 offset:30720
    v_mfma_f32_16x16x32_bf16 v[60:63], a[92:95], v[180:183], v[60:63]
    s_waitcnt vmcnt(10)
    v_mfma_f32_16x16x32_bf16 v[48:51], a[96:99], v[184:187], v[48:51]
    buffer_load_dwordx4 v[180:183], v130, s[24:27], s97 offen offset:1024 sc1
    v_mfma_f32_16x16x32_bf16 v[52:55], a[100:103], v[184:187], v[52:55]
    v_mfma_f32_16x16x32_bf16 v[56:59], a[104:107], v[184:187], v[56:59]
    v_mfma_f32_16x16x32_bf16 v[60:63], a[108:111], v[184:187], v[60:63]
    s_waitcnt lgkmcnt(0)
    v_add_f32 v208, v208, v212
    s_waitcnt vmcnt(10)
    v_mfma_f32_16x16x32_bf16 v[48:51], a[112:115], v[188:191], v[48:51]
    s_add_u32 s97, s62, s96
    buffer_load_dwordx4 v[184:187], v130, s[24:27], s97 offen offset:0 sc1
    v_mfma_f32_16x16x32_bf16 v[52:55], a[116:119], v[188:191], v[52:55]
    v_add_f32 v209, v209, v213
    v_mfma_f32_16x16x32_bf16 v[56:59], a[120:123], v[188:191], v[56:59]
    v_add_f32 v210, v210, v214
    v_mfma_f32_16x16x32_bf16 v[60:63], a[124:127], v[188:191], v[60:63]
    v_add_f32 v211, v211, v215
    s_waitcnt vmcnt(10)
    v_mfma_f32_16x16x32_bf16 v[48:51], a[128:131], v[192:195], v[48:51]
    buffer_load_dwordx4 v[188:191], v130, s[24:27], s97 offen offset:1024 sc1
    v_mfma_f32_16x16x32_bf16 v[52:55], a[132:135], v[192:195], v[52:55]
    v_add_f32 v216, v216, v220
    v_mfma_f32_16x16x32_bf16 v[56:59], a[136:139], v[192:195], v[56:59]
    v_add_f32 v217, v217, v221
    v_mfma_f32_16x16x32_bf16 v[60:63], a[140:143], v[192:195], v[60:63]
    v_add_f32 v218, v218, v222
    s_waitcnt vmcnt(10)
    v_mfma_f32_16x16x32_bf16 v[48:51], a[144:147], v[196:199], v[48:51]
    buffer_load_dwordx4 v[192:195], v130, s[24:27], s97 offen offset:2048 sc1
    v_mfma_f32_16x16x32_bf16 v[52:55], a[148:151], v[196:199], v[52:55]
    v_add_f32 v219, v219, v223
    v_mfma_f32_16x16x32_bf16 v[56:59], a[152:155], v[196:199], v[56:59]
    v_add_f32 v208, v208, v216
    v_mfma_f32_16x16x32_bf16 v[60:63], a[156:159], v[196:199], v[60:63]
    v_add_f32 v209, v209, v217
    s_waitcnt vmcnt(10)
    v_mfma_f32_16x16x32_bf16 v[48:51], a[160:163], v[200:203], v[48:51]
    buffer_load_dwordx4 v[196:199], v130, s[24:27], s97 offen offset:3072 sc1
    v_mfma_f32_16x16x32_bf16 v[52:55], a[164:167], v[200:203], v[52:55]
    v_add_f32 v210, v210, v218
    v_mfma_f32_16x16x32_bf16 v[56:59], a[168:171], v[200:203], v[56:59]
    v_add_f32 v211, v211, v219
    v_mfma_f32_16x16x32_bf16 v[60:63], a[172:175], v[200:203], v[60:63]
    v_cvt_pk_bf16_f32 v244, v208, v209
    s_waitcnt vmcnt(10)
    v_mfma_f32_16x16x32_bf16 v[48:51], a[176:179], v[204:207], v[48:51]
    s_add_u32 s97, s97, 4096
    buffer_load_dwordx4 v[200:203], v130, s[24:27], s97 offen offset:0 sc1
    v_mfma_f32_16x16x32_bf16 v[52:55], a[180:183], v[204:207], v[52:55]
    v_cvt_pk_bf16_f32 v245, v210, v211
    v_mfma_f32_16x16x32_bf16 v[56:59], a[184:187], v[204:207], v[56:59]
    v_mfma_f32_16x16x32_bf16 v[60:63], a[188:191], v[204:207], v[60:63]
    s_waitcnt vmcnt(10)
    v_mfma_f32_16x16x32_bf16 v[32:35], a[0:3], v[160:163], 0
    buffer_load_dwordx4 v[204:207], v130, s[24:27], s97 offen offset:1024 sc1
    v_mfma_f32_16x16x32_bf16 v[36:39], a[4:7], v[160:163], 0
    v_mfma_f32_16x16x32_bf16 v[40:43], a[8:11], v[160:163], 0
    v_mfma_f32_16x16x32_bf16 v[44:47], a[12:15], v[160:163], 0
    s_waitcnt vmcnt(10)
    v_mfma_f32_16x16x32_bf16 v[32:35], a[16:19], v[164:167], v[32:35]
    s_mul_i32 s62, s81, 49152
    s_add_u32 s97, s62, s53
    buffer_load_dwordx4 v[160:163], v130, s[24:27], s97 offen offset:0 sc1
    v_mfma_f32_16x16x32_bf16 v[36:39], a[20:23], v[164:167], v[36:39]
    ds_write_b128 v96, v[48:51] offset:4352
    v_mfma_f32_16x16x32_bf16 v[40:43], a[24:27], v[164:167], v[40:43]
    v_mfma_f32_16x16x32_bf16 v[44:47], a[28:31], v[164:167], v[44:47]
    ds_write_b128 v96, v[52:55] offset:4416
    s_waitcnt vmcnt(10)
    v_mfma_f32_16x16x32_bf16 v[32:35], a[32:35], v[168:171], v[32:35]
    buffer_load_dwordx4 v[164:167], v130, s[24:27], s97 offen offset:1024 sc1
    v_mfma_f32_16x16x32_bf16 v[36:39], a[36:39], v[168:171], v[36:39]
    v_mfma_f32_16x16x32_bf16 v[40:43], a[40:43], v[168:171], v[40:43]
    ds_write_b128 v96, v[56:59] offset:4480
    v_mfma_f32_16x16x32_bf16 v[44:47], a[44:47], v[168:171], v[44:47]
    s_waitcnt vmcnt(10)
    v_mfma_f32_16x16x32_bf16 v[32:35], a[48:51], v[172:175], v[32:35]
    buffer_load_dwordx4 v[168:171], v130, s[24:27], s97 offen offset:2048 sc1
LT_hop2:
    s_cbranch_execz LT_back
LW_hop2:
    s_cbranch_execz LW_back
    v_mfma_f32_16x16x32_bf16 v[36:39], a[52:55], v[172:175], v[36:39]
    ds_write_b128 v96, v[60:63] offset:4544
    v_mfma_f32_16x16x32_bf16 v[40:43], a[56:59], v[172:175], v[40:43]
    v_mfma_f32_16x16x32_bf16 v[44:47], a[60:63], v[172:175], v[44:47]
    s_waitcnt vmcnt(10)
    v_mfma_f32_16x16x32_bf16 v[32:35], a[64:67], v[176:179], v[32:35]
    buffer_load_dwordx4 v[172:175], v130, s[24:27], s97 offen offset:3072 sc1
    v_mfma_f32_16x16x32_bf16 v[36:39], a[68:71], v[176:179], v[36:39]
    s_waitcnt lgkmcnt(0)
    s_barrier
    v_mfma_f32_16x16x32_bf16 v[40:43], a[72:75], v[176:179], v[40:43]
    ds_read_b128 v[208:211], v97 offset:4352
    v_mfma_f32_16x16x32_bf16 v[44:47], a[76:79], v[176:179], v[44:47]
    ds_read_b128 v[212:215], v97 offset:14592
    s_waitcnt vmcnt(10)
    v_mfma_f32_16x16x32_bf16 v[32:35], a[80:83], v[180:183], v[32:35]
    s_add_u32 s97, s97, 4096
    buffer_load_dwordx4 v[176:179], v130, s[24:27], s97 offen offset:0 sc1
    v_mfma_f32_16x16x32_bf16 v[36:39], a[84:87], v[180:183], v[36:39]
    ds_read_b128 v[216:219], v97 offset:24832
    v_mfma_f32_16x16x32_bf16 v[40:43], a[88:91], v[180:183], v[40:43]
    ds_read_b128 v[220:223], v97 offset:35072
    v_mfma_f32_16x16x32_bf16 v[44:47], a[92:95], v[180:183], v[44:47]
    s_waitcnt vmcnt(10)
    v_mfma_f32_16x16x32_bf16 v[32:35], a[96:99], v[184:187], v[32:35]
    buffer_load_dwordx4 v[180:183], v130, s[24:27], s97 offen offset:1024 sc1
    v_mfma_f32_16x16x32_bf16 v[36:39], a[100:103], v[184:187], v[36:39]
    v_mfma_f32_16x16x32_bf16 v[40:43], a[104:107], v[184:187], v[40:43]
    v_mfma_f32_16x16x32_bf16 v[44:47], a[108:111], v[184:187], v[44:47]
    s_waitcnt lgkmcnt(0)
    v_add_f32 v208, v208, v212
    s_waitcnt vmcnt(10)
    v_mfma_f32_16x16x32_bf16 v[32:35], a[112:115], v[188:191], v[32:35]
    s_add_u32 s97, s62, s96
    buffer_load_dwordx4 v[184:187], v130, s[24:27], s97 offen offset:0 sc1
    v_mfma_f32_16x16x32_bf16 v[36:39], a[116:119], v[188:191], v[36:39]
    v_add_f32 v209, v209, v213
    v_mfma_f32_16x16x32_bf16 v[40:43], a[120:123], v[188:191], v[40:43]
    v_add_f32 v210, v210, v214
    v_mfma_f32_16x16x32_bf16 v[44:47], a[124:127], v[188:191], v[44:47]
    v_add_f32 v211, v211, v215
    s_waitcnt vmcnt(10)
    v_mfma_f32_16x16x32_bf16 v[32:35], a[128:131], v[192:195], v[32:35]
    buffer_load_dwordx4 v[188:191], v130, s[24:27], s97 offen offset:1024 sc1
    v_mfma_f32_16x16x32_bf16 v[36:39], a[132:135], v[192:195], v[36:39]
    v_add_f32 v216, v216, v220
    v_mfma_f32_16x16x32_bf16 v[40:43], a[136:139], v[192:195], v[40:43]
    v_add_f32 v217, v217, v221
    v_mfma_f32_16x16x32_bf16 v[44:47], a[140:143], v[192:195], v[44:47]
    v_add_f32 v218, v218, v222
    s_waitcnt vmcnt(10)
    v_mfma_f32_16x16x32_bf16 v[32:35], a[144:147], v[196:199], v[32:35]
    buffer_load_dwordx4 v[192:195], v130, s[24:27], s97 offen offset:2048 sc1
    v_mfma_f32_16x16x32_bf16 v[36:39], a[148:151], v[196:199], v[36:39]
    v_add_f32 v219, v219, v223
    v_mfma_f32_16x16x32_bf16 v[40:43], a[152:155], v[196:199], v[40:43]
    v_add_f32 v208, v208, v216
    v_mfma_f32_16x16x32_bf16 v[44:47], a[156:159], v[196:199], v[44:47]
    v_add_f32 v209, v209, v217
    s_waitcnt vmcnt(10)
    v_mfma_f32_16x16x32_bf16 v[32:35], a[160:163], v[200:203], v[32:35]
    buffer_load_dwordx4 v[196:199], v130, s[24:27], s97 offen offset:3072 sc1
    v_mfma_f32_16x16x32_bf16 v[36:39], a[164:167], v[200:203], v[36:39]
    v_add_f32 v210, v210, v218
    v_mfma_f32_16x16x32_bf16 v[40:43], a[168:171], v[200:203], v[40:43]
    v_add_f32 v211, v211, v219
    v_mfma_f32_16x16x32_bf16 v[44:47], a[172:175], v[200:203], v[44:47]
    v_cvt_pk_bf16_f32 v246, v208, v209
    s_waitcnt vmcnt(10)
    v_mfma_f32_16x16x32_bf16 v[32:35], a[176:179], v[204:207], v[32:35]
    s_add_u32 s97, s97, 4096
    buffer_load_dwordx4 v[200:203], v130, s[24:27], s97 offen offset:0 sc1
    v_mfma_f32_16x16x32_bf16 v[36:39], a[180:183], v[204:207], v[36:39]
    v_cvt_pk_bf16_f32 v247, v210, v211
    v_mfma_f32_16x16x32_bf16 v[40:43], a[184:187], v[204:207], v[40:43]
    v_mfma_f32_16x16x32_bf16 v[44:47], a[188:191], v[204:207], v[44:47]
    s_cmp_eq_u32 s83, 5
    s_cbranch_scc1 L_tail5
    s_waitcnt vmcnt(10)
    v_mfma_f32_16x16x32_bf16 v[48:51], a[0:3], v[160:163], 0
    buffer_load_dwordx4 v[204:207], v130, s[24:27], s97 offen offset:1024 sc1
    v_mfma_f32_16x16x32_bf16 v[52:55], a[4:7], v[160:163], 0
    v_mfma_f32_16x16x32_bf16 v[56:59], a[8:11], v[160:163], 0
    v_mfma_f32_16x16x32_bf16 v[60:63], a[12:15], v[160:163], 0
    s_waitcnt vmcnt(10)
    v_mfma_f32_16x16x32_bf16 v[48:51], a[16:19], v[164:167], v[48:51]
    v_mfma_f32_16x16x32_bf16 v[52:55], a[20:23], v[164:167], v[52:55]
    ds_write_b128 v96, v[32:35] offset:0
    v_mfma_f32_16x16x32_bf16 v[56:59], a[24:27], v[164:167], v[56:59]
    s_mul_i32 s61, s76, 20480
    buffer_store_dwordx2 v[240:241], v98, s[28:31], s61 offen sc1
    v_mfma_f32_16x16x32_bf16 v[60:63], a[28:31], v[164:167], v[60:63]
    ds_write_b128 v96, v[36:39] offset:64
    s_waitcnt vmcnt(10)
    v_mfma_f32_16x16x32_bf16 v[48:51], a[32:35], v[168:171], v[48:51]
    v_mfma_f32_16x16x32_bf16 v[52:55], a[36:39], v[168:171], v[52:55]
    v_mfma_f32_16x16x32_bf16 v[56:59], a[40:43], v[168:171], v[56:59]
    s_mul_i32 s61, s77, 20480
    buffer_store_dwordx2 v[242:243], v98, s[28:31], s61 offen sc1
    ds_write_b128 v96, v[40:43] offset:128
    v_mfma_f32_16x16x32_bf16 v[60:63], a[44:47], v[168:171], v[60:63]
    s_waitcnt vmcnt(10)
    v_mfma_f32_16x16x32_bf16 v[48:51], a[48:51], v[172:175], v[48:51]
    v_mfma_f32_16x16x32_bf16 v[52:55], a[52:55], v[172:175], v[52:55]
    ds_write_b128 v96, v[44:47] offset:192
    v_mfma_f32_16x16x32_bf16 v[56:59], a[56:59], v[172:175], v[56:59]
    s_mul_i32 s61, s78, 20480
    buffer_store_dwordx2 v[244:245], v98, s[28:31], s61 offen sc1
    v_mfma_f32_16x16x32_bf16 v[60:63], a[60:63], v[172:175], v[60:63]
    s_waitcnt vmcnt(10)
    v_mfma_f32_16x16x32_bf16 v[48:51], a[64:67], v[176:179], v[48:51]
    v_mfma_f32_16x16x32_bf16 v[52:55], a[68:71], v[176:179], v[52:55]
    s_waitcnt lgkmcnt(0)
    s_barrier
    v_mfma_f32_16x16x32_bf16 v[56:59], a[72:75], v[176:179], v[56:59]
    s_mul_i32 s61, s79, 20480
    buffer_store_dwordx2 v[246:247], v98, s[28:31], s61 offen sc1
    ds_read_b128 v[208:211], v97 offset:0
    v_mfma_f32_16x16x32_bf16 v[60:63], a[76:79], v[176:179], v[60:63]
    ds_read_b128 v[212:215], v97 offset:10240
    s_waitcnt vmcnt(10)
    v_mfma_f32_16x16x32_bf16 v[48:51], a[80:83], v[180:183], v[48:51]
    v_mfma_f32_16x16x32_bf16 v[52:55], a[84:87], v[180:183], v[52:55]
    ds_read_b128 v[216:219], v97 offset:20480
    v_mfma_f32_16x16x32_bf16 v[56:59], a[88:91], v[180:183], v[56:59]
    ds_read_b128 v[220:223], v97 offset:30720
    v_mfma_f32_16x16x32_bf16 v[60:63], a[92:95], v[180:183], v[60:63]
    s_waitcnt vmcnt(9)
    v_mfma_f32_16x16x32_bf16 v[48:51], a[96:99], v[184:187], v[48:51]
    v_mfma_f32_16x16x32_bf16 v[52:55], a[100:103], v[184:187], v[52:55]
    v_mfma_f32_16x16x32_bf16 v[56:59], a[104:107], v[184:187], v[56:59]
    v_mfma_f32_16x16x32_bf16 v[60:63], a[108:111], v[184:187], v[60:63]
    s_waitcnt lgkmcnt(0)
    v_add_f32 v208, v208, v212
    s_waitcnt vmcnt(8)
    v_mfma_f32_16x16x32_bf16 v[48:51], a[112:115], v[188:191], v[48:51]
    v_mfma_f32_16x16x32_bf16 v[52:55], a[116:119], v[188:191], v[52:55]
    v_add_f32 v209, v209, v213
    v_mfma_f32_16x16x32_bf16 v[56:59], a[120:123], v[188:191], v[56:59]
    v_add_f32 v210, v210, v214
    v_mfma_f32_16x16x32_bf16 v[60:63], a[124:127], v[188:191], v[60:63]
    v_add_f32 v211, v211, v215
    s_waitcnt vmcnt(7)
    v_mfma_f32_16x16x32_bf16 v[48:51], a[128:131], v[192:195], v[48:51]
    v_mfma_f32_16x16x32_bf16 v[52:55], a[132:135], v[192:195], v[52:55]
    v_add_f32 v216, v216, v220
    v_mfma_f32_16x16x32_bf16 v[56:59], a[136:139], v[192:195], v[56:59]
    v_add_f32 v217, v217, v221
    v_mfma_f32_16x16x32_bf16 v[60:63], a[140:143], v[192:195], v[60:63]
    v_add_f32 v218, v218, v222
    s_waitcnt vmcnt(6)
    v_mfma_f32_16x16x32_bf16 v[48:51], a[144:147], v[196:199], v[48:51]
    v_mfma_f32_16x16x32_bf16 v[52:55], a[148:151], v[196:199], v[52:55]
    v_add_f32 v219, v219, v223
    v_mfma_f32_16x16x32_bf16 v[56:59], a[152:155], v[196:199], v[56:59]
    v_add_f32 v208, v208, v216
    v_mfma_f32_16x16x32_bf16 v[60:63], a[156:159], v[196:199], v[60:63]
    v_add_f32 v209, v209, v217
    s_waitcnt vmcnt(5)
    v_mfma_f32_16x16x32_bf16 v[48:51], a[160:163], v[200:203], v[48:51]
    v_mfma_f32_16x16x32_bf16 v[52:55], a[164:167], v[200:203], v[52:55]
    v_add_f32 v210, v210, v218
    v_mfma_f32_16x16x32_bf16 v[56:59], a[168:171], v[200:203], v[56:59]
    v_add_f32 v211, v211, v219
    v_mfma_f32_16x16x32_bf16 v[60:63], a[172:175], v[200:203], v[60:63]
    v_cvt_pk_bf16_f32 v248, v208, v209
    s_waitcnt vmcnt(4)
    v_mfma_f32_16x16x32_bf16 v[48:51], a[176:179], v[204:207], v[48:51]
    v_mfma_f32_16x16x32_bf16 v[52:55], a[180:183], v[204:207], v[52:55]
    v_cvt_pk_bf16_f32 v249, v210, v211
    v_mfma_f32_16x16x32_bf16 v[56:59], a[184:187], v[204:207], v[56:59]
    s_mul_i32 s61, s80, 20480
    buffer_store_dwordx2 v[248:249], v98, s[28:31], s61 offen sc1
    v_mfma_f32_16x16x32_bf16 v[60:63], a[188:191], v[204:207], v[60:63]
    s_nop 4
    ds_write_b128 v96, v[48:51] offset:4352
    ds_write_b128 v96, v[52:55] offset:4416
    ds_write_b128 v96, v[56:59] offset:4480
    ds_write_b128 v96, v[60:63] offset:4544
    s_waitcnt lgkmcnt(0)
    s_barrier
    ds_read_b128 v[208:211], v97 offset:4352
    ds_read_b128 v[212:215], v97 offset:14592
    ds_read_b128 v[216:219], v97 offset:24832
    ds_read_b128 v[220:223], v97 offset:35072
    s_waitcnt lgkmcnt(2)
    v_pk_add_f32 v[208:209], v[208:209], v[212:213]
    v_pk_add_f32 v[210:211], v[210:211], v[214:215]
    s_waitcnt lgkmcnt(0)
    v_pk_add_f32 v[216:217], v[216:217], v[220:221]
    v_pk_add_f32 v[218:219], v[218:219], v[222:223]
    v_pk_add_f32 v[208:209], v[208:209], v[216:217]
    v_pk_add_f32 v[210:211], v[210:211], v[218:219]
    v_cvt_pk_bf16_f32 v250, v208, v209
    v_cvt_pk_bf16_f32 v251, v210, v211
    s_mul_i32 s61, s81, 20480
    buffer_store_dwordx2 v[250:251], v98, s[28:31], s61 offen sc1
L_fin:
L_end:
    s_endpgm
L_tail5:
LT_hopA:
    s_cbranch_execz LT_back
    s_mul_i32 s61, s76, 20480
    buffer_store_dwordx2 v[240:241], v98, s[28:31], s61 offen sc1
    s_mul_i32 s61, s77, 20480
    buffer_store_dwordx2 v[242:243], v98, s[28:31], s61 offen sc1
    s_mul_i32 s61, s78, 20480
    buffer_store_dwordx2 v[244:245], v98, s[28:31], s61 offen sc1
    s_mul_i32 s61, s79, 20480
    buffer_store_dwordx2 v[246:247], v98, s[28:31], s61 offen sc1
    s_nop 4
    ds_write_b128 v96, v[32:35] offset:0
    ds_write_b128 v96, v[36:39] offset:64
    ds_write_b128 v96, v[40:43] offset:128
    ds_write_b128 v96, v[44:47] offset:192
    s_waitcnt lgkmcnt(0)
    s_barrier
    ds_read_b128 v[208:211], v97 offset:0
    ds_read_b128 v[212:215], v97 offset:10240
    ds_read_b128 v[216:219], v97 offset:20480
    ds_read_b128 v[220:223], v97 offset:30720
    s_waitcnt lgkmcnt(2)
    v_pk_add_f32 v[208:209], v[208:209], v[212:213]
    v_pk_add_f32 v[210:211], v[210:211], v[214:215]
    s_waitcnt lgkmcnt(0)
    v_pk_add_f32 v[216:217], v[216:217], v[220:221]
    v_pk_add_f32 v[218:219], v[218:219], v[222:223]
    v_pk_add_f32 v[208:209], v[208:209], v[216:217]
    v_pk_add_f32 v[210:211], v[210:211], v[218:219]
    v_cvt_pk_bf16_f32 v248, v208, v209
    v_cvt_pk_bf16_f32 v249, v210, v211
    s_mul_i32 s61, s80, 20480
    buffer_store_dwordx2 v[248:249], v98, s[28:31], s61 offen sc1
    s_endpgm
L_again1:
    s_mov_b32 s94, 100000
L_spin1:
    buffer_load_dwordx2 v[26:27], v29, s[24:27], 0 offen sc1
    s_sub_u32 s94, s94, 1
    s_cbranch_scc1 L_ok1
    s_waitcnt vmcnt(0)
    v_cmp_ne_u64 vcc, v[24:25], v[26:27]
    s_nop 1
    s_and_b64 s[58:59], vcc, s[70:71]
    s_cbranch_scc1 L_spin1
    s_branch L_ok1
L_again2:
    s_mov_b32 s94, 100000
L_spin2:
    buffer_load_dwordx2 v[26:27], v29, s[24:27], 0 offen sc1
    s_sub_u32 s94, s94, 1
    s_cbranch_scc1 L_ok2
    s_waitcnt vmcnt(0)
    v_cmp_ne_u64 vcc, v[24:25], v[26:27]
    s_nop 1
    s_and_b64 s[58:59], vcc, s[72:73]
    s_cbranch_scc1 L_spin2
    s_branch L_ok2
L_again3:
    s_mov_b32 s94, 100000
L_spin3:
    buffer_load_dwordx2 v[26:27], v29, s[24:27], 0 offen sc1
    s_sub_u32 s94, s94, 1
    s_cbranch_scc1 L_ok3
    s_waitcnt vmcnt(0)
    v_cmp_ne_u64 vcc, v[24:25], v[26:27]
    s_nop 1
    s_and_b64 s[58:59], vcc, s[74:75]
    s_cbranch_scc1 L_spin3
    s_branch L_ok3
LT_tag_again:
    s_mov_b32 s94, 100000
LT_tag_spin:
    buffer_store_dwordx2 v[120:121], v119, s[32:35], 0 offen sc1
    buffer_load_dwordx2 v[24:25], v30, s[32:35], 0 offen sc1
    s_sub_u32 s94, s94, 1
    s_cbranch_scc1 LT_tag_ok
    s_waitcnt vmcnt(0)
    v_cmp_eq_u32 vcc, 0, v25
    s_nop 1
    s_cbranch_vccnz LT_tag_spin
    s_branch LT_tag_ok
L_wide:
    v_lshrrev_b32 v108, 3, v1
    v_mad_u32_u24 v108, v107, 32, v108
    v_mul_u32_u24 v108, 1280, v108
    v_lshrrev_b32 v109, 4, v1
    v_and_b32 v110, 7, v1
    v_xor_b32 v31, v110, v109
    v_lshl_add_u32 v2, v31, 4, v108
    v_xor_b32 v31, 4, v31
    v_lshl_add_u32 v3, v31, 4, v108
    v_add_u32 v4, 18432, v2
    v_add_u32 v3, 9216, v3
    v_add_u32 v5, 18432, v3
    s_lshr_b32 s5, s39, 2
    s_lshl_b32 s5, s5, 1
    s_add_u32 s5, s5, s54
    s_sub_u32 s5, s5, 30
    s_and_b32 s4, s39, 3
    s_lshl_b32 s38, s4, 2
    s_add_u32 s38, s38, s5
    s_mov_b32 s50, 2457600
    s_lshl_b32 s43, s36, 12
    s_mul_i32 s51, s38, 192
    s_mul_i32 s44, s36, 3072
    s_add_u32 s45, s44, 28672
    s_add_u32 s44, s44, 16384
    v_mul_u32_u24 v107, 49152, v107
    v_mul_u32_u24 v108, 43691, v1
    v_lshrrev_b32 v108, 19, v108
    v_mul_u32_u24 v109, 12, v108
    v_sub_u32 v109, v1, v109
    v_lshrrev_b32 v110, 2, v108
    v_and_b32 v110, 2, v110
    v_xor_b32 v109, v109, v110
    v_mul_u32_u24 v108, 3072, v108
    v_add_u32 v108, v107, v108
    v_lshl_add_u32 v6, v109, 4, v108
    v_add_u32 v31, 64, v1
    v_mul_u32_u24 v108, 43691, v31
    v_lshrrev_b32 v108, 19, v108
    v_mul_u32_u24 v109, 12, v108
    v_sub_u32 v109, v31, v109
    v_lshrrev_b32 v110, 2, v108
    v_and_b32 v110, 2, v110
    v_xor_b32 v109, v109, v110
    v_mul_u32_u24 v108, 3072, v108
    v_add_u32 v108, v107, v108
    v_subrev_u32 v108, 1024, v108
    v_lshl_add_u32 v7, v109, 4, v108
    v_add_u32 v31, 128, v1
    v_mul_u32_u24 v108, 43691, v31
    v_lshrrev_b32 v108, 19, v108
    v_mul_u32_u24 v109, 12, v108
    v_sub_u32 v109, v31, v109
    v_lshrrev_b32 v110, 2, v108
    v_and_b32 v110, 2, v110
    v_xor_b32 v109, v109, v110
    v_mul_u32_u24 v108, 3072, v108
    v_add_u32 v108, v107, v108
    v_subrev_u32 v108, 2048, v108
    v_lshl_add_u32 v8, v109, 4, v108
    s_lshr_b32 s58, s4, 1
    s_add_u32 s58, s58, s4
    s_lshr_b32 s59, s39, 2
    s_lshl_b32 s59, s59, 1
    s_add_u32 s58, s58, s59
    s_sub_u32 s59, s58, 10
    s_cmp_ge_u32 s58, 10
    s_cselect_b32 s58, s59, s58
    s_lshl_b32 s40, s58, 7
    s_add_u32 s40, s40, s50
    s_mul_i32 s41, s58, 196608
    s_add_u32 s41, s41, s51
    s_add_u32 s55, s50, 1280
    s_mov_b32 s42, 0
    s_waitcnt lgkmcnt(0)
    s_add_u32 m0, s42, s43
    s_nop 0
    buffer_load_dwordx4 v2, s[8:11], s40 offen offset:0 lds
    buffer_load_dwordx4 v3, s[8:11], s40 offen offset:1024 lds
    buffer_load_dwordx4 v4, s[8:11], s40 offen offset:2048 lds
    buffer_load_dwordx4 v5, s[8:11], s40 offen offset:3072 lds
    s_add_u32 m0, s42, s44
    s_nop 0
    buffer_load_dwordx4 v6, s[12:15], s41 offen offset:0 lds
    buffer_load_dwordx4 v7, s[12:15], s41 offen offset:1024 lds
    buffer_load_dwordx4 v8, s[12:15], s41 offen offset:2048 lds
    s_add_u32 m0, s42, s45
    s_nop 0
    buffer_load_dwordx4 v6, s[16:19], s41 offen offset:0 lds
    buffer_load_dwordx4 v7, s[16:19], s41 offen offset:1024 lds
    buffer_load_dwordx4 v8, s[16:19], s41 offen offset:2048 lds
    s_add_u32 s40, s40, 128
    s_add_u32 s41, s41, 196608
    s_cmp_eq_u32 s40, s55
    s_cselect_b32 s40, s50, s40
    s_cselect_b32 s41, s51, s41
    s_add_u32 s42, s42, 40960
    s_cmp_eq_u32 s42, 122880
    s_cselect_b32 s42, 0, s42
    s_mov_b32 s34, 256
    s_mov_b32 s35, 0x20000
    v_mov_b32 v30, 0
    v_mov_b32 v119, 0x40000000
    s_and_b32 s101, s39, 6
    s_add_u32 s101, s101, s54
    s_sub_u32 s101, s101, 30
    s_cmp_lt_u32 s101, 5
    s_cselect_b32 s59, 24, 25
    s_and_b32 s60, s39, 1
    s_mul_i32 s60, s60, 5
    s_add_u32 s101, s101, s60
    s_getpc_b64 s[66:67]
LW_tp:
    s_lshl_b32 s60, s59, 6
    s_add_u32 s60, s60, L_table-LW_tp
    s_add_u32 s66, s66, s60
    s_addc_u32 s67, s67, 0
    s_load_dwordx16 s[68:83], s[66:67], 0
    s_mov_b64 exec, 0
    s_cmp_eq_u32 s36, 0
    s_cbranch_scc1 LW_hop9
    s_cmp_eq_u32 s36, 1
    s_cbranch_scc1 LW_hop1
    s_cmp_eq_u32 s36, 2
    s_cbranch_scc1 LW_hop2
    s_branch LW_hopB
LW_back:
    s_mov_b64 exec, -1
    s_add_u32 m0, s42, s43
    s_nop 0
    buffer_load_dwordx4 v2, s[8:11], s40 offen offset:0 lds
    s_mov_b32 s46, 0
    s_mov_b32 s49, 40960
    s_mov_b32 s100, 196608
    s_mov_b32 s98, 0xffe50000
    s_lshr_b32 s63, s36, 1
    s_and_b32 s64, s36, 1
    v_and_b32 v107, 15, v1
    v_lshrrev_b32 v108, 4, v1
    buffer_load_dwordx4 v3, s[8:11], s40 offen offset:1024 lds
    v_bfe_u32 v109, v1, 1, 3
    v_xor_b32 v109, v109, v108
    s_mul_i32 s65, s63, 8192
    v_lshlrev_b32 v110, 7, v107
    v_add_u32 v110, s65, v110
    v_lshl_add_u32 v12, v109, 4, v110
    v_xor_b32 v31, 4, v109
    v_lshl_add_u32 v13, v31, 4, v110
    buffer_load_dwordx4 v4, s[8:11], s40 offen offset:2048 lds
    v_bfe_u32 v110, v1, 4, 1
    v_bfe_u32 v109, v1, 2, 2
    v_lshl_add_u32 v31, v108, 3, v109
    v_mul_u32_u24 v31, 192, v31
    v_and_b32 v111, 3, v1
    v_lshl_add_u32 v31, v111, 3, v31
    s_mul_i32 s65, s64, 3
    v_xor_b32 v107, s65, v110
    buffer_load_dwordx4 v5, s[8:11], s40 offen offset:3072 lds
    v_lshl_add_u32 v16, v107, 5, v31
    s_add_u32 s60, s65, 1
    v_xor_b32 v107, s60, v110
    v_lshl_add_u32 v17, v107, 5, v31
    s_add_u32 s60, s65, 2
    v_xor_b32 v107, s60, v110
    v_lshl_add_u32 v18, v107, 5, v31
    s_mul_i32 s88, s2, 10240
    s_add_u32 m0, s42, s44
    s_nop 0
    buffer_load_dwordx4 v6, s[12:15], s41 offen offset:0 lds
    s_add_u32 s88, s88, 384
    s_lshr_b32 s60, s39, 2
    s_lshl_b32 s60, s60, 5
    s_add_u32 s60, s60, s54
    s_mul_i32 s60, s60, 3072
    s_mul_i32 s61, s4, 768
    s_add_u32 s60, s60, s61
    s_add_u32 s60, s60, 589824
    buffer_load_dwordx4 v7, s[12:15], s41 offen offset:1024 lds
    s_lshr_b32 s61, s39, 1
    s_lshl_b32 s61, s61, 5
    s_add_u32 s61, s61, s54
    s_mul_i32 s61, s61, 15360
    s_and_b32 s62, s39, 1
    s_mul_i32 s62, s62, 640
    s_add_u32 s61, s61, s62
    s_mov_b32 s89, 196608
    buffer_load_dwordx4 v8, s[12:15], s41 offen offset:2048 lds
    s_mov_b32 s62, 5
    s_mov_b32 s90, 128
    s_mov_b32 s91, 0
    s_cmp_eq_u32 s36, 3
    s_cselect_b32 s60, s61, s60
    s_cselect_b32 s89, 2560, s89
    s_cselect_b32 s62, 9, s62
    s_cselect_b32 s91, 640, s91
    s_cselect_b64 s[92:93], s[20:21], s[12:13]
    s_add_u32 m0, s42, s45
    s_nop 0
    buffer_load_dwordx4 v6, s[16:19], s41 offen offset:0 lds
    s_cmp_eq_u32 s36, 2
    s_cselect_b64 s[92:93], s[16:17], s[92:93]
    s_cmp_eq_u32 s36, 0
    s_cselect_b32 s88, s88, s60
    s_cselect_b32 s89, 128, s89
    s_cselect_b32 s62, 7, s62
    s_cselect_b32 s90, 1280, s90
    s_cselect_b64 s[92:93], s[8:9], s[92:93]
    s_cselect_b32 s94, s10, s14
    buffer_load_dwordx4 v7, s[16:19], s41 offen offset:1024 lds
    s_mov_b32 s95, 0x20000
    v_min_u32 v90, s62, v1
    v_mul_u32_u24 v91, 13108, v90
    v_lshrrev_b32 v91, 16, v91
    v_mul_u32_u24 v91, s91, v91
    v_mad_u32_u24 v90, v90, s90, v91
    s_mul_i32 s90, s89, 7
    s_cmp_eq_u32 s36, 3
    s_cselect_b32 s90, 15360, s90
    buffer_load_dwordx4 v8, s[16:19], s41 offen offset:2048 lds
    s_add_u32 s90, s90, s88
    s_cmp_eq_u32 s36, 3
    s_cselect_b32 s88, s88, 0x40000000
    s_add_u32 s40, s40, 128
    s_add_u32 s41, s41, 196608
    s_cmp_eq_u32 s40, s55
    s_cselect_b32 s40, s50, s40
    s_cselect_b32 s41, s51, s41
    s_add_u32 s42, s42, 40960
    s_cmp_eq_u32 s42, 122880
    s_cselect_b32 s42, 0, s42
    s_waitcnt vmcnt(10) lgkmcnt(0)
    s_barrier
    ds_read_b64_tr_b16 v[64:65], v16 offset:16384
    ds_read_b64_tr_b16 v[66:67], v16 offset:17152
    ds_read_b64_tr_b16 v[68:69], v16 offset:28672
    s_add_u32 s46, s46, 40960
    s_cmp_eq_u32 s46, 122880
    s_cselect_b32 s47, 0xfffec000, s49
    s_cselect_b32 s46, 0, s46
    ds_read_b64_tr_b16 v[70:71], v16 offset:29440
    ds_read_b128 v[32:35], v12 offset:0
    ds_read_b128 v[36:39], v12 offset:2048
    ds_read_b64_tr_b16 v[72:73], v17 offset:16384
    ds_read_b64_tr_b16 v[74:75], v17 offset:17152
    ds_read_b128 v[40:43], v12 offset:4096
    ds_read_b128 v[44:47], v12 offset:6144
    ds_read_b64_tr_b16 v[76:77], v17 offset:28672
    v_add_u32 v12, s47, v12
    ds_read_b64_tr_b16 v[78:79], v17 offset:29440
    buffer_load_dwordx2 v[24:25], v30, s[32:35], 0 offen sc1
    ds_read_b64_tr_b16 v[80:81], v18 offset:16384
    ds_read_b64_tr_b16 v[82:83], v18 offset:17152
    s_add_u32 m0, s42, s43
    s_nop 0
    buffer_load_dwordx4 v2, s[8:11], s40 offen offset:0 lds
    buffer_load_dwordx4 v3, s[8:11], s40 offen offset:1024 lds
    ds_read_b64_tr_b16 v[84:85], v18 offset:28672
    s_waitcnt lgkmcnt(5)
    v_mfma_f32_16x16x32_bf16 v[160:163], v[64:67], v[32:35], 0
    ds_read_b64_tr_b16 v[86:87], v18 offset:29440
    s_mov_b32 s22, 1966080
    s_mov_b32 s23, 0x20000
    v_mfma_f32_16x16x32_bf16 v[164:167], v[64:67], v[36:39], 0
    ds_read_b128 v[48:51], v13 offset:0
    s_mov_b32 s26, 9437184
    s_mov_b32 s27, 0x20000
    v_mfma_f32_16x16x32_bf16 v[208:211], v[64:67], v[40:43], 0
    ds_read_b128 v[52:55], v13 offset:2048
    s_mov_b32 s30, 2621440
    s_mov_b32 s31, 0x20000
    v_mfma_f32_16x16x32_bf16 v[212:215], v[64:67], v[44:47], 0
    ds_read_b64_tr_b16 v[64:65], v16 offset:22528
    s_mul_i32 s7, s36, 10240
    s_and_b32 s60, s59, 1
    v_mfma_f32_16x16x32_bf16 v[220:223], v[68:71], v[44:47], 0
    ds_read_b64_tr_b16 v[66:67], v16 offset:23296
    s_mul_i32 s60, s60, 6
    s_mul_i32 s61, s36, 12
    v_mfma_f32_16x16x32_bf16 v[216:219], v[68:71], v[40:43], 0
    ds_read_b128 v[56:59], v13 offset:4096
    s_add_u32 s53, s61, s60
    s_xor_b32 s60, s60, 6
    v_mfma_f32_16x16x32_bf16 v[172:175], v[68:71], v[36:39], 0
    ds_read_b128 v[60:63], v13 offset:6144
    s_add_u32 s96, s61, s60
    s_mul_i32 s56, s53, 40960
    v_mfma_f32_16x16x32_bf16 v[168:171], v[68:71], v[32:35], 0
    ds_read_b64_tr_b16 v[68:69], v16 offset:34816
    v_add_u32 v13, s47, v13
    s_mul_i32 s6, s96, 40960
    v_mfma_f32_16x16x32_bf16 v[176:179], v[72:75], v[32:35], 0
    ds_read_b64_tr_b16 v[70:71], v16 offset:35584
    s_lshl_b32 s53, s53, 10
    s_lshl_b32 s96, s96, 10
    v_mfma_f32_16x16x32_bf16 v[180:183], v[72:75], v[36:39], 0
    buffer_load_dwordx4 v4, s[8:11], s40 offen offset:2048 lds
    v_add_u32 v16, s47, v16
    s_lshl_b32 s60, s101, 7
    v_mfma_f32_16x16x32_bf16 v[224:227], v[72:75], v[40:43], 0
    buffer_load_dwordx4 v5, s[8:11], s40 offen offset:3072 lds
    s_cmp_eq_u32 s59, 25
    s_cselect_b32 s60, 0x40000000, s60
    v_mfma_f32_16x16x32_bf16 v[228:231], v[72:75], v[44:47], 0
    ds_read_b64_tr_b16 v[72:73], v17 offset:22528
    s_add_u32 s40, s40, 128
    s_waitcnt lgkmcnt(11)
    v_mfma_f32_16x16x32_bf16 v[236:239], v[76:79], v[44:47], 0
    ds_read_b64_tr_b16 v[74:75], v17 offset:23296
    s_add_u32 m0, s42, s44
    s_add_u32 s56, s56, s60
    v_mfma_f32_16x16x32_bf16 v[232:235], v[76:79], v[40:43], 0
    buffer_load_dwordx4 v6, s[12:15], s41 offen offset:0 lds
    s_add_u32 s6, s6, s60
    v_lshlrev_b32 v130, 4, v1
    v_mfma_f32_16x16x32_bf16 v[188:191], v[76:79], v[36:39], 0
    buffer_load_dwordx4 v7, s[12:15], s41 offen offset:1024 lds
    v_lshrrev_b32 v107, 3, v1
    v_mfma_f32_16x16x32_bf16 v[184:187], v[76:79], v[32:35], 0
    ds_read_b64_tr_b16 v[76:77], v17 offset:34816
    v_mul_u32_u24 v107, 1280, v107
    v_mfma_f32_16x16x32_bf16 v[192:195], v[80:83], v[32:35], 0
    ds_read_b64_tr_b16 v[78:79], v17 offset:35584
    v_lshlrev_b32 v108, 1, v108
    v_mfma_f32_16x16x32_bf16 v[196:199], v[80:83], v[36:39], 0
    buffer_load_dwordx4 v8, s[12:15], s41 offen offset:2048 lds
    v_add_u32 v17, s47, v17
    v_mfma_f32_16x16x32_bf16 v[240:243], v[80:83], v[40:43], 0
    s_cmp_eq_u32 s40, s55
    s_cselect_b32 s40, s50, s40
    s_cselect_b32 s99, s98, s100
    v_mfma_f32_16x16x32_bf16 v[244:247], v[80:83], v[44:47], 0
    ds_read_b64_tr_b16 v[80:81], v18 offset:22528
    v_and_b32 v31, 7, v1
    s_waitcnt lgkmcnt(13)
    v_mfma_f32_16x16x32_bf16 v[252:255], v[84:87], v[44:47], 0
    ds_read_b64_tr_b16 v[82:83], v18 offset:23296
    s_add_u32 m0, s42, s45
    v_xor_b32 v31, v31, v108
    v_mfma_f32_16x16x32_bf16 v[248:251], v[84:87], v[40:43], 0
    buffer_load_dwordx4 v6, s[16:19], s41 offen offset:0 lds
    v_lshl_add_u32 v9, v31, 4, v107
    v_mfma_f32_16x16x32_bf16 v[204:207], v[84:87], v[36:39], 0
    buffer_load_dwordx4 v7, s[16:19], s41 offen offset:1024 lds
    v_add_u32 v10, 9216, v9
    v_mfma_f32_16x16x32_bf16 v[200:203], v[84:87], v[32:35], 0
    ds_read_b64_tr_b16 v[84:85], v18 offset:34816
    v_add_u32 v11, 18432, v9
    s_waitcnt lgkmcnt(5)
    v_mfma_f32_16x16x32_bf16 v[160:163], v[64:67], v[48:51], v[160:163]
    ds_read_b64_tr_b16 v[86:87], v18 offset:35584
    v_add_u32 v14, 27648, v9
    v_mfma_f32_16x16x32_bf16 v[164:167], v[64:67], v[52:55], v[164:167]
    buffer_load_dwordx4 v8, s[16:19], s41 offen offset:2048 lds
    v_add_u32 v18, s47, v18
    v_mfma_f32_16x16x32_bf16 v[208:211], v[64:67], v[56:59], v[208:211]
    s_add_u32 s41, s41, s99
    v_lshrrev_b32 v107, 5, v1
    v_lshlrev_b32 v107, 4, v107
    v_mfma_f32_16x16x32_bf16 v[212:215], v[64:67], v[60:63], v[212:215]
    s_add_u32 s42, s42, 40960
    s_cmp_eq_u32 s42, 122880
    s_cselect_b32 s42, 0, s42
    v_mfma_f32_16x16x32_bf16 v[220:223], v[68:71], v[60:63], v[220:223]
    v_lshl_add_u32 v107, v110, 2, v107
    v_add_u32 v107, v107, v109
    v_lshlrev_b32 v107, 7, v107
    v_lshl_add_u32 v107, v111, 3, v107
    v_add_u32 v107, s7, v107
    v_bfe_u32 v31, v1, 3, 2
    v_lshl_add_u32 v100, v31, 5, v107
    v_add_u32 v99, 0x10000, v100
    v_xor_b32 v108, 1, v31
    v_lshl_add_u32 v101, v108, 5, v107
    v_add_u32 v104, 0x10000, v101
    v_xor_b32 v108, 2, v31
    v_lshl_add_u32 v102, v108, 5, v107
    v_add_u32 v105, 0x10000, v102
    v_xor_b32 v108, 3, v31
    v_lshl_add_u32 v103, v108, 5, v107
    v_add_u32 v106, 0x10000, v103
    buffer_load_dword v91, v90, s[92:95], s88 offen
    s_add_u32 s88, s88, s89
    s_waitcnt vmcnt(12) lgkmcnt(0)
    s_barrier
LW_hop9:
    s_cbranch_execz LW_back
    s_mov_b32 s48, 7
LW_loop:
    v_mfma_f32_16x16x32_bf16 v[216:219], v[68:71], v[56:59], v[216:219]
    ds_read_b64_tr_b16 v[64:65], v16 offset:16384
    v_mfma_f32_16x16x32_bf16 v[172:175], v[68:71], v[52:55], v[172:175]
    ds_read_b64_tr_b16 v[66:67], v16 offset:17152
    v_mfma_f32_16x16x32_bf16 v[168:171], v[68:71], v[48:51], v[168:171]
    ds_read_b64_tr_b16 v[68:69], v16 offset:28672
    s_add_u32 m0, s42, s43
    v_mfma_f32_16x16x32_bf16 v[176:179], v[72:75], v[48:51], v[176:179]
    buffer_load_dwordx4 v2, s[8:11], s40 offen offset:0 lds
    s_add_u32 s46, s46, 40960
    s_cmp_eq_u32 s46, 122880
    v_mfma_f32_16x16x32_bf16 v[180:183], v[72:75], v[52:55], v[180:183]
    s_cselect_b32 s47, 0xfffec000, s49
    s_cselect_b32 s46, 0, s46
    ds_read_b64_tr_b16 v[70:71], v16 offset:29440
    v_mfma_f32_16x16x32_bf16 v[224:227], v[72:75], v[56:59], v[224:227]
    ds_read_b128 v[32:35], v12 offset:0
    s_sub_u32 s48, s48, 1
    v_mfma_f32_16x16x32_bf16 v[228:231], v[72:75], v[60:63], v[228:231]
    ds_read_b64_tr_b16 v[72:73], v17 offset:16384
    v_mfma_f32_16x16x32_bf16 v[236:239], v[76:79], v[60:63], v[236:239]
    ds_read_b64_tr_b16 v[74:75], v17 offset:17152
    v_mfma_f32_16x16x32_bf16 v[232:235], v[76:79], v[56:59], v[232:235]
    buffer_load_dwordx4 v3, s[8:11], s40 offen offset:1024 lds
    v_mfma_f32_16x16x32_bf16 v[188:191], v[76:79], v[52:55], v[188:191]
    ds_read_b128 v[36:39], v12 offset:2048
    v_mfma_f32_16x16x32_bf16 v[184:187], v[76:79], v[48:51], v[184:187]
    ds_read_b64_tr_b16 v[76:77], v17 offset:28672
    v_mfma_f32_16x16x32_bf16 v[192:195], v[80:83], v[48:51], v[192:195]
    ds_read_b64_tr_b16 v[78:79], v17 offset:29440
    v_mfma_f32_16x16x32_bf16 v[196:199], v[80:83], v[52:55], v[196:199]
    buffer_load_dwordx4 v4, s[8:11], s40 offen offset:2048 lds
    v_mfma_f32_16x16x32_bf16 v[240:243], v[80:83], v[56:59], v[240:243]
    ds_read_b128 v[40:43], v12 offset:4096
    v_mfma_f32_16x16x32_bf16 v[244:247], v[80:83], v[60:63], v[244:247]
    ds_read_b64_tr_b16 v[80:81], v18 offset:16384
    v_mfma_f32_16x16x32_bf16 v[252:255], v[84:87], v[60:63], v[252:255]
    ds_read_b64_tr_b16 v[82:83], v18 offset:17152
    v_mfma_f32_16x16x32_bf16 v[248:251], v[84:87], v[56:59], v[248:251]
    buffer_load_dwordx4 v5, s[8:11], s40 offen offset:3072 lds
    v_mfma_f32_16x16x32_bf16 v[204:207], v[84:87], v[52:55], v[204:207]
    ds_read_b128 v[44:47], v12 offset:6144
    s_add_u32 s40, s40, 128
    v_mfma_f32_16x16x32_bf16 v[200:203], v[84:87], v[48:51], v[200:203]
    ds_read_b64_tr_b16 v[84:85], v18 offset:28672
    v_add_u32 v12, s47, v12
    s_waitcnt lgkmcnt(1)
    v_mfma_f32_16x16x32_bf16 v[160:163], v[64:67], v[32:35], v[160:163]
    ds_read_b64_tr_b16 v[86:87], v18 offset:29440
    v_mfma_f32_16x16x32_bf16 v[164:167], v[64:67], v[36:39], v[164:167]
    ds_read_b128 v[48:51], v13 offset:0
    s_add_u32 m0, s42, s44
    v_mfma_f32_16x16x32_bf16 v[208:211], v[64:67], v[40:43], v[208:211]
    buffer_load_dwordx4 v6, s[12:15], s41 offen offset:0 lds
    v_mfma_f32_16x16x32_bf16 v[212:215], v[64:67], v[44:47], v[212:215]
    ds_read_b64_tr_b16 v[64:65], v16 offset:22528
    v_mfma_f32_16x16x32_bf16 v[220:223], v[68:71], v[44:47], v[220:223]
    ds_read_b64_tr_b16 v[66:67], v16 offset:23296
    v_mfma_f32_16x16x32_bf16 v[216:219], v[68:71], v[40:43], v[216:219]
    ds_read_b128 v[52:55], v13 offset:2048
    v_mfma_f32_16x16x32_bf16 v[172:175], v[68:71], v[36:39], v[172:175]
    buffer_load_dwordx4 v7, s[12:15], s41 offen offset:1024 lds
    v_mfma_f32_16x16x32_bf16 v[168:171], v[68:71], v[32:35], v[168:171]
    ds_read_b64_tr_b16 v[68:69], v16 offset:34816
    v_mfma_f32_16x16x32_bf16 v[176:179], v[72:75], v[32:35], v[176:179]
    ds_read_b64_tr_b16 v[70:71], v16 offset:35584
    v_mfma_f32_16x16x32_bf16 v[180:183], v[72:75], v[36:39], v[180:183]
    ds_read_b128 v[56:59], v13 offset:4096
    v_add_u32 v16, s47, v16
    v_mfma_f32_16x16x32_bf16 v[224:227], v[72:75], v[40:43], v[224:227]
    buffer_load_dwordx4 v8, s[12:15], s41 offen offset:2048 lds
    v_mfma_f32_16x16x32_bf16 v[228:231], v[72:75], v[44:47], v[228:231]
    ds_read_b64_tr_b16 v[72:73], v17 offset:22528
    v_mfma_f32_16x16x32_bf16 v[236:239], v[76:79], v[44:47], v[236:239]
    ds_read_b64_tr_b16 v[74:75], v17 offset:23296
    v_mfma_f32_16x16x32_bf16 v[232:235], v[76:79], v[40:43], v[232:235]
    ds_read_b128 v[60:63], v13 offset:6144
    s_add_u32 m0, s42, s45
    v_mfma_f32_16x16x32_bf16 v[188:191], v[76:79], v[36:39], v[188:191]
    buffer_load_dwordx4 v6, s[16:19], s41 offen offset:0 lds
    v_add_u32 v13, s47, v13
    v_mfma_f32_16x16x32_bf16 v[184:187], v[76:79], v[32:35], v[184:187]
    ds_read_b64_tr_b16 v[76:77], v17 offset:34816
    v_mfma_f32_16x16x32_bf16 v[192:195], v[80:83], v[32:35], v[192:195]
    ds_read_b64_tr_b16 v[78:79], v17 offset:35584
    v_mfma_f32_16x16x32_bf16 v[196:199], v[80:83], v[36:39], v[196:199]
    v_add_u32 v17, s47, v17
    v_mfma_f32_16x16x32_bf16 v[240:243], v[80:83], v[40:43], v[240:243]
    buffer_load_dwordx4 v7, s[16:19], s41 offen offset:1024 lds
    v_mfma_f32_16x16x32_bf16 v[244:247], v[80:83], v[44:47], v[244:247]
    ds_read_b64_tr_b16 v[80:81], v18 offset:22528
    s_waitcnt lgkmcnt(13)
    v_mfma_f32_16x16x32_bf16 v[252:255], v[84:87], v[44:47], v[252:255]
    ds_read_b64_tr_b16 v[82:83], v18 offset:23296
    v_mfma_f32_16x16x32_bf16 v[248:251], v[84:87], v[40:43], v[248:251]
    s_cmp_eq_u32 s40, s55
    s_cselect_b32 s40, s50, s40
    s_cselect_b32 s99, s98, s100
    v_mfma_f32_16x16x32_bf16 v[204:207], v[84:87], v[36:39], v[204:207]
    buffer_load_dwordx4 v8, s[16:19], s41 offen offset:2048 lds
    v_mfma_f32_16x16x32_bf16 v[200:203], v[84:87], v[32:35], v[200:203]
    ds_read_b64_tr_b16 v[84:85], v18 offset:34816
    s_add_u32 s41, s41, s99
    s_waitcnt lgkmcnt(5)
    v_mfma_f32_16x16x32_bf16 v[160:163], v[64:67], v[48:51], v[160:163]
    ds_read_b64_tr_b16 v[86:87], v18 offset:35584
    v_mfma_f32_16x16x32_bf16 v[164:167], v[64:67], v[52:55], v[164:167]
    v_add_u32 v18, s47, v18
    v_mfma_f32_16x16x32_bf16 v[208:211], v[64:67], v[56:59], v[208:211]
    buffer_load_dword v91, v90, s[92:95], s88 offen
    s_add_u32 s88, s88, s89
    v_mfma_f32_16x16x32_bf16 v[212:215], v[64:67], v[60:63], v[212:215]
    s_cmp_ge_u32 s88, s90
    s_cselect_b32 s88, 0x40000000, s88
    v_mfma_f32_16x16x32_bf16 v[220:223], v[68:71], v[60:63], v[220:223]
    s_add_u32 s42, s42, 40960
    s_cmp_eq_u32 s42, 122880
    s_cselect_b32 s42, 0, s42
    s_cmp_lg_u32 s48, 0
    s_waitcnt vmcnt(12) lgkmcnt(0)
    s_barrier
    s_cbranch_scc1 LW_loop
LW_post:
    v_cmp_eq_u32 vcc, 0, v25
    s_nop 1
    s_cbranch_vccnz LW_tag_again
LW_tag_ok:
    v_mfma_f32_16x16x32_bf16 v[216:219], v[68:71], v[56:59], v[216:219]
    ds_read_b64_tr_b16 v[64:65], v16 offset:16384
    v_lshrrev_b32 v107, 5, v1
    v_mfma_f32_16x16x32_bf16 v[172:175], v[68:71], v[52:55], v[172:175]
    ds_read_b64_tr_b16 v[66:67], v16 offset:17152
    v_mul_u32_u24 v107, 49152, v107
    v_mfma_f32_16x16x32_bf16 v[168:171], v[68:71], v[48:51], v[168:171]
    ds_read_b64_tr_b16 v[68:69], v16 offset:28672
    s_add_u32 s46, s46, 40960
    s_cmp_eq_u32 s46, 122880
    v_mfma_f32_16x16x32_bf16 v[176:179], v[72:75], v[48:51], v[176:179]
    s_cselect_b32 s47, 0xfffec000, s49
    s_cselect_b32 s46, 0, s46
    ds_read_b64_tr_b16 v[70:71], v16 offset:29440
    v_mfma_f32_16x16x32_bf16 v[180:183], v[72:75], v[52:55], v[180:183]
    ds_read_b128 v[32:35], v12 offset:0
    v_and_b32 v108, 31, v1
    v_mfma_f32_16x16x32_bf16 v[224:227], v[72:75], v[56:59], v[224:227]
    ds_read_b128 v[36:39], v12 offset:2048
    v_lshl_add_u32 v19, v108, 4, v107
    v_mfma_f32_16x16x32_bf16 v[228:231], v[72:75], v[60:63], v[228:231]
    ds_read_b64_tr_b16 v[72:73], v17 offset:16384
    v_mov_b32 v20, 0xbdd2d3e8
    v_mfma_f32_16x16x32_bf16 v[236:239], v[76:79], v[60:63], v[236:239]
    ds_read_b64_tr_b16 v[74:75], v17 offset:17152
    v_mov_b32 v21, 0xbdd2d3e8
    v_mfma_f32_16x16x32_bf16 v[232:235], v[76:79], v[56:59], v[232:235]
    ds_read_b128 v[40:43], v12 offset:4096
    v_mov_b32 v22, 0xc0135761
    v_mfma_f32_16x16x32_bf16 v[188:191], v[76:79], v[52:55], v[188:191]
    ds_read_b128 v[44:47], v12 offset:6144
    v_mov_b32 v23, 0xc0135761
    v_mfma_f32_16x16x32_bf16 v[184:187], v[76:79], v[48:51], v[184:187]
    ds_read_b64_tr_b16 v[76:77], v17 offset:28672
    v_add_u32 v12, s47, v12
    v_mfma_f32_16x16x32_bf16 v[192:195], v[80:83], v[48:51], v[192:195]
    ds_read_b64_tr_b16 v[78:79], v17 offset:29440
    v_and_b32 v107, 1, v1
    s_lshl_b32 s60, s63, 1
    v_mfma_f32_16x16x32_bf16 v[196:199], v[80:83], v[52:55], v[196:199]
    s_add_u32 m0, s7, 122880
    s_nop 0
    buffer_load_dwordx4 v9, s[20:23], s56 offen offset:0 lds
    s_add_u32 s60, s60, 60
    s_mul_i32 s88, s60, 98304
    v_mfma_f32_16x16x32_bf16 v[240:243], v[80:83], v[56:59], v[240:243]
    buffer_load_dwordx4 v10, s[20:23], s56 offen offset:1024 lds
    s_lshl_b32 s61, s38, 1
    s_add_u32 s61, s61, s64
    v_mfma_f32_16x16x32_bf16 v[244:247], v[80:83], v[60:63], v[244:247]
    ds_read_b64_tr_b16 v[80:81], v18 offset:16384
    s_mul_i32 s61, s61, 1536
    v_mfma_f32_16x16x32_bf16 v[252:255], v[84:87], v[60:63], v[252:255]
    ds_read_b64_tr_b16 v[82:83], v18 offset:17152
    s_add_u32 s88, s88, s61
    s_add_u32 s89, s88, 512
    v_mfma_f32_16x16x32_bf16 v[248:251], v[84:87], v[56:59], v[248:251]
    buffer_load_dwordx4 v11, s[20:23], s56 offen offset:2048 lds
    s_add_u32 s90, s88, 1024
    s_add_u32 s91, s88, 98304
    v_mfma_f32_16x16x32_bf16 v[204:207], v[84:87], v[52:55], v[204:207]
    buffer_load_dwordx4 v14, s[20:23], s56 offen offset:3072 lds
    s_add_u32 s92, s89, 98304
    s_add_u32 s93, s90, 98304
    v_mfma_f32_16x16x32_bf16 v[200:203], v[84:87], v[48:51], v[200:203]
    ds_read_b64_tr_b16 v[84:85], v18 offset:28672
    s_lshl_b32 s60, s60, 2
    s_waitcnt lgkmcnt(5)
    v_mfma_f32_16x16x32_bf16 v[160:163], v[64:67], v[32:35], v[160:163]
    ds_read_b64_tr_b16 v[86:87], v18 offset:29440
    s_add_u32 s60, s60, s4
    s_lshl_b32 s60, s60, 4
    v_mfma_f32_16x16x32_bf16 v[164:167], v[64:67], v[36:39], v[164:167]
    ds_read_b128 v[48:51], v13 offset:0
    s_lshl_b32 s61, s5, 1
    s_add_u32 s61, s61, s64
    v_mfma_f32_16x16x32_bf16 v[208:211], v[64:67], v[40:43], v[208:211]
    ds_read_b128 v[52:55], v13 offset:2048
    s_add_u32 s60, s60, s61
    s_lshl_b32 s60, s60, 3
    v_mfma_f32_16x16x32_bf16 v[212:215], v[64:67], v[44:47], v[212:215]
    ds_read_b64_tr_b16 v[64:65], v16 offset:22528
    s_add_u32 s60, s60, 6291456
    v_mfma_f32_16x16x32_bf16 v[220:223], v[68:71], v[44:47], v[220:223]
    ds_read_b64_tr_b16 v[66:67], v16 offset:23296
    s_cmp_lt_u32 s61, 4
    s_cselect_b32 s61, 64, 0
    v_mfma_f32_16x16x32_bf16 v[216:219], v[68:71], v[40:43], v[216:219]
    ds_read_b128 v[56:59], v13 offset:4096
    v_mul_u32_u24 v107, s61, v107
    v_mfma_f32_16x16x32_bf16 v[172:175], v[68:71], v[36:39], v[172:175]
    ds_read_b128 v[60:63], v13 offset:6144
    v_add_u32 v133, s60, v107
    v_mfma_f32_16x16x32_bf16 v[168:171], v[68:71], v[32:35], v[168:171]
    ds_read_b64_tr_b16 v[68:69], v16 offset:34816
    v_add_u32 v13, s47, v13
    v_mfma_f32_16x16x32_bf16 v[176:179], v[72:75], v[32:35], v[176:179]
    ds_read_b64_tr_b16 v[70:71], v16 offset:35584
    v_add_u32 v134, 512, v133
    v_mfma_f32_16x16x32_bf16 v[180:183], v[72:75], v[36:39], v[180:183]
    s_add_u32 m0, s7, 126976
    s_add_u32 s56, s56, 40960
    buffer_load_dwordx4 v9, s[20:23], s56 offen offset:0 lds
    v_add_u32 v16, s47, v16
    v_mfma_f32_16x16x32_bf16 v[224:227], v[72:75], v[40:43], v[224:227]
    buffer_load_dwordx4 v10, s[20:23], s56 offen offset:1024 lds
    v_mfma_f32_16x16x32_bf16 v[228:231], v[72:75], v[44:47], v[228:231]
    ds_read_b64_tr_b16 v[72:73], v17 offset:22528
    s_waitcnt lgkmcnt(11)
    v_mfma_f32_16x16x32_bf16 v[236:239], v[76:79], v[44:47], v[236:239]
    ds_read_b64_tr_b16 v[74:75], v17 offset:23296
    v_mfma_f32_16x16x32_bf16 v[232:235], v[76:79], v[40:43], v[232:235]
    v_mfma_f32_16x16x32_bf16 v[188:191], v[76:79], v[36:39], v[188:191]
    v_mfma_f32_16x16x32_bf16 v[184:187], v[76:79], v[32:35], v[184:187]
    ds_read_b64_tr_b16 v[76:77], v17 offset:34816
    v_mfma_f32_16x16x32_bf16 v[192:195], v[80:83], v[32:35], v[192:195]
    ds_read_b64_tr_b16 v[78:79], v17 offset:35584
    v_mfma_f32_16x16x32_bf16 v[196:199], v[80:83], v[36:39], v[196:199]
    buffer_load_dwordx4 v11, s[20:23], s56 offen offset:2048 lds
    v_add_u32 v17, s47, v17
    v_mfma_f32_16x16x32_bf16 v[240:243], v[80:83], v[40:43], v[240:243]
    v_mfma_f32_16x16x32_bf16 v[244:247], v[80:83], v[44:47], v[244:247]
    ds_read_b64_tr_b16 v[80:81], v18 offset:22528
    s_waitcnt lgkmcnt(13)
    v_mfma_f32_16x16x32_bf16 v[252:255], v[84:87], v[44:47], v[252:255]
    ds_read_b64_tr_b16 v[82:83], v18 offset:23296
    v_mfma_f32_16x16x32_bf16 v[248:251], v[84:87], v[40:43], v[248:251]
    v_mfma_f32_16x16x32_bf16 v[204:207], v[84:87], v[36:39], v[204:207]
    buffer_load_dwordx4 v14, s[20:23], s56 offen offset:3072 lds
    v_mfma_f32_16x16x32_bf16 v[200:203], v[84:87], v[32:35], v[200:203]
    ds_read_b64_tr_b16 v[84:85], v18 offset:34816
    s_waitcnt lgkmcnt(5)
    v_mfma_f32_16x16x32_bf16 v[160:163], v[64:67], v[48:51], v[160:163]
    ds_read_b64_tr_b16 v[86:87], v18 offset:35584
    v_mfma_f32_16x16x32_bf16 v[164:167], v[64:67], v[52:55], v[164:167]
    v_add_u32 v18, s47, v18
    v_mfma_f32_16x16x32_bf16 v[208:211], v[64:67], v[56:59], v[208:211]
    v_mfma_f32_16x16x32_bf16 v[212:215], v[64:67], v[60:63], v[212:215]
    v_mfma_f32_16x16x32_bf16 v[220:223], v[68:71], v[60:63], v[220:223]
    s_waitcnt vmcnt(9) lgkmcnt(0)
    s_barrier
    v_mfma_f32_16x16x32_bf16 v[216:219], v[68:71], v[56:59], v[216:219]
    ds_read_b64_tr_b16 v[64:65], v16 offset:16384
    s_lshr_b32 s60, s83, 8
    s_and_b32 s83, s83, 7
    v_mfma_f32_16x16x32_bf16 v[172:175], v[68:71], v[52:55], v[172:175]
    ds_read_b64_tr_b16 v[66:67], v16 offset:17152
    v_lshrrev_b32 v107, 4, v1
    v_mfma_f32_16x16x32_bf16 v[168:171], v[68:71], v[48:51], v[168:171]
    ds_read_b64_tr_b16 v[68:69], v16 offset:28672
    v_min_u32 v107, s60, v107
    v_mfma_f32_16x16x32_bf16 v[176:179], v[72:75], v[48:51], v[176:179]
    ds_read_b64_tr_b16 v[70:71], v16 offset:29440
    v_and_b32 v108, 15, v1
    v_mfma_f32_16x16x32_bf16 v[180:183], v[72:75], v[52:55], v[180:183]
    ds_read_b128 v[32:35], v12 offset:0
    v_min_u32 v108, 11, v108
    v_mfma_f32_16x16x32_bf16 v[224:227], v[72:75], v[56:59], v[224:227]
    ds_read_b128 v[36:39], v12 offset:2048
    v_lshlrev_b32 v108, 3, v108
    s_lshl_b32 s60, s36, 7
    v_mfma_f32_16x16x32_bf16 v[228:231], v[72:75], v[60:63], v[228:231]
    ds_read_b64_tr_b16 v[72:73], v17 offset:16384
    s_add_u32 s60, s60, s82
    v_mfma_f32_16x16x32_bf16 v[236:239], v[76:79], v[60:63], v[236:239]
    ds_read_b64_tr_b16 v[74:75], v17 offset:17152
    s_add_u32 s60, s60, 6291456
    v_add_u32 v108, s60, v108
    v_mfma_f32_16x16x32_bf16 v[232:235], v[76:79], v[56:59], v[232:235]
    ds_read_b128 v[40:43], v12 offset:4096
    v_lshl_add_u32 v29, v107, 9, v108
    v_mfma_f32_16x16x32_bf16 v[188:191], v[76:79], v[52:55], v[188:191]
    ds_read_b128 v[44:47], v12 offset:6144
    v_cmp_gt_u32 vcc, 32, v1
    v_mfma_f32_16x16x32_bf16 v[184:187], v[76:79], v[48:51], v[184:187]
    ds_read_b64_tr_b16 v[76:77], v17 offset:28672
    v_mov_b32 v107, s68
    v_mfma_f32_16x16x32_bf16 v[192:195], v[80:83], v[48:51], v[192:195]
    ds_read_b64_tr_b16 v[78:79], v17 offset:29440
    v_mov_b32 v109, s69
    v_mfma_f32_16x16x32_bf16 v[196:199], v[80:83], v[52:55], v[196:199]
    s_add_u32 m0, s7, 40960
    s_add_u32 s56, s56, 40960
    buffer_load_dwordx4 v9, s[20:23], s56 offen offset:0 lds
    v_cndmask_b32 v107, v109, v107, vcc
    v_mfma_f32_16x16x32_bf16 v[240:243], v[80:83], v[56:59], v[240:243]
    buffer_load_dwordx4 v10, s[20:23], s56 offen offset:1024 lds
    v_add_u32 v28, v107, v108
    s_add_u32 s62, s7, 40960
    v_mfma_f32_16x16x32_bf16 v[244:247], v[80:83], v[60:63], v[244:247]
    ds_read_b64_tr_b16 v[80:81], v18 offset:16384
    v_and_b32 v107, 15, v1
    v_mfma_f32_16x16x32_bf16 v[252:255], v[84:87], v[60:63], v[252:255]
    ds_read_b64_tr_b16 v[82:83], v18 offset:17152
    v_mul_u32_u24 v107, 272, v107
    v_mfma_f32_16x16x32_bf16 v[248:251], v[84:87], v[56:59], v[248:251]
    buffer_load_dwordx4 v11, s[20:23], s56 offen offset:2048 lds
    v_lshrrev_b32 v108, 4, v1
    v_mfma_f32_16x16x32_bf16 v[204:207], v[84:87], v[52:55], v[204:207]
    buffer_load_dwordx4 v14, s[20:23], s56 offen offset:3072 lds
    v_lshl_add_u32 v107, v108, 4, v107
    v_mfma_f32_16x16x32_bf16 v[200:203], v[84:87], v[48:51], v[200:203]
    ds_read_b64_tr_b16 v[84:85], v18 offset:28672
    v_add_u32 v96, s62, v107
    s_waitcnt lgkmcnt(5)
    v_mfma_f32_16x16x32_bf16 v[160:163], v[64:67], v[32:35], v[160:163]
    ds_read_b64_tr_b16 v[86:87], v18 offset:29440
    v_and_b32 v109, 15, v1
    s_mul_i32 s62, s36, 1088
    v_mfma_f32_16x16x32_bf16 v[164:167], v[64:67], v[36:39], v[164:167]
    ds_read_b128 v[48:51], v13 offset:0
    s_add_u32 s62, s62, 40960
    v_mul_u32_u24 v107, 272, v108
    v_mfma_f32_16x16x32_bf16 v[208:211], v[64:67], v[40:43], v[208:211]
    ds_read_b128 v[52:55], v13 offset:2048
    v_lshl_add_u32 v107, v109, 4, v107
    v_mfma_f32_16x16x32_bf16 v[212:215], v[64:67], v[44:47], v[212:215]
    ds_read_b64_tr_b16 v[64:65], v16 offset:22528
    v_add_u32 v97, s62, v107
    v_mfma_f32_16x16x32_bf16 v[220:223], v[68:71], v[44:47], v[220:223]
    ds_read_b64_tr_b16 v[66:67], v16 offset:23296
    v_mul_u32_u24 v108, 1280, v108
    v_mfma_f32_16x16x32_bf16 v[216:219], v[68:71], v[40:43], v[216:219]
    ds_read_b128 v[56:59], v13 offset:4096
    v_lshl_add_u32 v98, v109, 3, v108
    s_mul_i32 s60, s36, 5120
    v_mfma_f32_16x16x32_bf16 v[172:175], v[68:71], v[36:39], v[172:175]
    ds_read_b128 v[60:63], v13 offset:6144
    s_lshl_b32 s61, s101, 7
    s_add_u32 s60, s60, s61
    v_mfma_f32_16x16x32_bf16 v[168:171], v[68:71], v[32:35], v[168:171]
    ds_read_b64_tr_b16 v[68:69], v16 offset:34816
    v_add_u32 v98, s60, v98
    v_mfma_f32_16x16x32_bf16 v[176:179], v[72:75], v[32:35], v[176:179]
    ds_read_b64_tr_b16 v[70:71], v16 offset:35584
    v_mfma_f32_16x16x32_bf16 v[180:183], v[72:75], v[36:39], v[180:183]
    s_add_u32 m0, s7, 45056
    s_add_u32 s56, s56, 40960
    buffer_load_dwordx4 v9, s[20:23], s56 offen offset:0 lds
    v_mfma_f32_16x16x32_bf16 v[224:227], v[72:75], v[40:43], v[224:227]
    buffer_load_dwordx4 v10, s[20:23], s56 offen offset:1024 lds
    v_mfma_f32_16x16x32_bf16 v[228:231], v[72:75], v[44:47], v[228:231]
    ds_read_b64_tr_b16 v[72:73], v17 offset:22528
    s_waitcnt lgkmcnt(11)
    v_mfma_f32_16x16x32_bf16 v[236:239], v[76:79], v[44:47], v[236:239]
    ds_read_b64_tr_b16 v[74:75], v17 offset:23296
    v_mfma_f32_16x16x32_bf16 v[232:235], v[76:79], v[40:43], v[232:235]
    buffer_load_dwordx4 v11, s[20:23], s56 offen offset:2048 lds
    v_mfma_f32_16x16x32_bf16 v[188:191], v[76:79], v[36:39], v[188:191]
    buffer_load_dwordx4 v14, s[20:23], s56 offen offset:3072 lds
    v_mfma_f32_16x16x32_bf16 v[184:187], v[76:79], v[32:35], v[184:187]
    ds_read_b64_tr_b16 v[76:77], v17 offset:34816
    v_mfma_f32_16x16x32_bf16 v[192:195], v[80:83], v[32:35], v[192:195]
    ds_read_b64_tr_b16 v[78:79], v17 offset:35584
    v_mfma_f32_16x16x32_bf16 v[196:199], v[80:83], v[36:39], v[196:199]
    s_add_u32 m0, s7, 81920
    s_add_u32 s56, s56, 40960
    buffer_load_dwordx4 v9, s[20:23], s56 offen offset:0 lds
    v_mfma_f32_16x16x32_bf16 v[240:243], v[80:83], v[40:43], v[240:243]
    buffer_load_dwordx4 v10, s[20:23], s56 offen offset:1024 lds
    v_mfma_f32_16x16x32_bf16 v[244:247], v[80:83], v[44:47], v[244:247]
    ds_read_b64_tr_b16 v[80:81], v18 offset:22528
    s_waitcnt lgkmcnt(13)
    v_mfma_f32_16x16x32_bf16 v[252:255], v[84:87], v[44:47], v[252:255]
    ds_read_b64_tr_b16 v[82:83], v18 offset:23296
    v_mfma_f32_16x16x32_bf16 v[248:251], v[84:87], v[40:43], v[248:251]
    s_waitcnt vmcnt(14)
    ds_read_b64_tr_b16 a[0:1], v99 offset:57344
    v_mfma_f32_16x16x32_bf16 v[204:207], v[84:87], v[36:39], v[204:207]
    ds_read_b64_tr_b16 a[2:3], v99 offset:58368
    v_mfma_f32_16x16x32_bf16 v[200:203], v[84:87], v[32:35], v[200:203]
    ds_read_b64_tr_b16 v[84:85], v18 offset:34816
    ds_read_b64_tr_b16 v[86:87], v18 offset:35584
    s_waitcnt lgkmcnt(14)
    v_mfma_f32_16x16x32_bf16 v[160:163], v[64:67], v[48:51], v[160:163]
    v_mfma_f32_16x16x32_bf16 v[164:167], v[64:67], v[52:55], v[164:167]
    s_waitcnt lgkmcnt(10)
    v_mfma_f32_16x16x32_bf16 v[168:171], v[68:71], v[48:51], v[168:171]
    ds_read_b64_tr_b16 a[4:5], v104 offset:57344
    v_mfma_f32_16x16x32_bf16 v[172:175], v[68:71], v[52:55], v[172:175]
    ds_read_b64_tr_b16 a[6:7], v104 offset:58368
    s_waitcnt lgkmcnt(10)
    v_mfma_f32_16x16x32_bf16 v[176:179], v[72:75], v[48:51], v[176:179]
    ds_read_b64_tr_b16 a[8:9], v105 offset:57344
    v_mfma_f32_16x16x32_bf16 v[180:183], v[72:75], v[52:55], v[180:183]
    ds_read_b64_tr_b16 a[10:11], v105 offset:58368
    s_waitcnt lgkmcnt(10)
    v_mfma_f32_16x16x32_bf16 v[184:187], v[76:79], v[48:51], v[184:187]
    ds_read_b64_tr_b16 a[12:13], v106 offset:57344
    v_mfma_f32_16x16x32_bf16 v[188:191], v[76:79], v[52:55], v[188:191]
    ds_read_b64_tr_b16 a[14:15], v106 offset:58368
    s_waitcnt lgkmcnt(10)
    v_mfma_f32_16x16x32_bf16 v[192:195], v[80:83], v[48:51], v[192:195]
    v_mfma_f32_16x16x32_bf16 v[196:199], v[80:83], v[52:55], v[196:199]
    s_waitcnt lgkmcnt(6)
    v_mfma_f32_16x16x32_bf16 v[200:203], v[84:87], v[48:51], v[200:203]
    v_mfma_f32_16x16x32_bf16 v[204:207], v[84:87], v[52:55], v[204:207]
    v_mfma_f32_16x16x32_bf16 v[208:211], v[64:67], v[56:59], v[208:211]
    v_mfma_f32_16x16x32_bf16 v[212:215], v[64:67], v[60:63], v[212:215]
    v_mfma_f32_16x16x32_bf16 v[216:219], v[68:71], v[56:59], v[216:219]
    v_mfma_f32_16x16x32_bf16 v[220:223], v[68:71], v[60:63], v[220:223]
    v_mfma_f32_16x16x32_bf16 v[224:227], v[72:75], v[56:59], v[224:227]
    v_mfma_f32_16x16x32_bf16 v[228:231], v[72:75], v[60:63], v[228:231]
    v_mfma_f32_16x16x32_bf16 v[232:235], v[76:79], v[56:59], v[232:235]
    v_mfma_f32_16x16x32_bf16 v[236:239], v[76:79], v[60:63], v[236:239]
    v_mfma_f32_16x16x32_bf16 v[240:243], v[80:83], v[56:59], v[240:243]
    v_mfma_f32_16x16x32_bf16 v[244:247], v[80:83], v[60:63], v[244:247]
    v_mfma_f32_16x16x32_bf16 v[248:251], v[84:87], v[56:59], v[248:251]
    v_mfma_f32_16x16x32_bf16 v[252:255], v[84:87], v[60:63], v[252:255]
    s_waitcnt lgkmcnt(0)
    s_branch L_gate
LW_tag_again:
    s_mov_b32 s94, 100000
LW_tag_spin:
    buffer_load_dwordx2 v[24:25], v30, s[32:35], 0 offen sc1
    s_sub_u32 s94, s94, 1
    s_cbranch_scc1 LW_tag_ok
    s_waitcnt vmcnt(0)
    v_cmp_eq_u32 vcc, 0, v25
    s_nop 1
    s_cbranch_vccnz LW_tag_spin
    s_branch LW_tag_ok
.p2align 6
.type L_table,@object
L_table:
    .long 0x0, 0x0, 0xffff0000, 0x0, 0xffff0000, 0x0, 0x0, 0xffff, 0x0, 0x1, 0x2, 0x3, 0x4, 0x8000, 0x0, 0x205
    .long 0x200, 0x200, 0x0, 0xffff, 0x0, 0xffff, 0xffff, 0x0, 0x6, 0x7, 0x8, 0x9, 0x5, 0x8000, 0x400, 0x205
    .long 0x200, 0x200, 0x0, 0xffff, 0xffff, 0x0, 0xffff, 0x0, 0xc, 0xd, 0xe, 0xa, 0xb, 0x8000, 0xa00, 0x205
    .long 0x0, 0x400, 0x0, 0xffff, 0xffff0000, 0x0, 0xffff0000, 0x0, 0xf, 0x12, 0x13, 0x10, 0x11, 0x8000, 0xe00, 0x205
    .long 0x0, 0x0, 0x0, 0xffff, 0xffff0000, 0x0, 0xffff0000, 0x0, 0x14, 0x15, 0x18, 0x16, 0x17, 0x8000, 0x1400, 0x205
    .long 0x0, 0x200, 0xffff0000, 0x0, 0x0, 0xffff, 0x0, 0xffff, 0x19, 0x1a, 0x1b, 0x1c, 0x1d, 0x8000, 0x1800, 0x205
    .long 0x0, 0x0, 0xffff0000, 0x0, 0xffff0000, 0x0, 0x0, 0xffff, 0x1e, 0x1f, 0x20, 0x21, 0x22, 0x8000, 0x1e00, 0x205
    .long 0x200, 0x200, 0x0, 0xffff, 0x0, 0xffff, 0xffff, 0x0, 0x24, 0x25, 0x26, 0x27, 0x23, 0x8000, 0x2200, 0x205
    .long 0x200, 0x200, 0x0, 0xffff, 0xffff, 0x0, 0xffff, 0x0, 0x2a, 0x2b, 0x2c, 0x28, 0x29, 0x8000, 0x2800, 0x205
    .long 0x0, 0x400, 0x0, 0xffff, 0xffff0000, 0x0, 0xffff0000, 0x0, 0x2d, 0x30, 0x31, 0x2e, 0x2f, 0x8000, 0x2c00, 0x205
    .long 0x0, 0x0, 0x0, 0xffff, 0xffff0000, 0x0, 0xffff0000, 0x0, 0x32, 0x33, 0x36, 0x34, 0x35, 0x8000, 0x3200, 0x205
    .long 0x0, 0x200, 0xffff0000, 0x0, 0x0, 0xffff, 0x0, 0xffff, 0x37, 0x38, 0x39, 0x3a, 0x3b, 0x8000, 0x3600, 0x205
    .long 0x0, 0x0, 0xffff0000, 0x0, 0xffff0000, 0x0, 0x0, 0xffff, 0x3c, 0x3d, 0x3e, 0x3f, 0x40, 0x8000, 0x3c00, 0x205
    .long 0x200, 0x200, 0x0, 0xffff, 0x0, 0xffff, 0xffff, 0x0, 0x42, 0x43, 0x44, 0x45, 0x41, 0x8000, 0x4000, 0x205
    .long 0x200, 0x200, 0x0, 0xffff, 0xffff, 0x0, 0xffff, 0x0, 0x48, 0x49, 0x4a, 0x46, 0x47, 0x8000, 0x4600, 0x205
    .long 0x0, 0x400, 0x0, 0xffff, 0xffff0000, 0x0, 0xffff0000, 0x0, 0x4b, 0x4e, 0x4f, 0x4c, 0x4d, 0x8000, 0x4a00, 0x205
    .long 0x0, 0x0, 0x0, 0xffff, 0xffff0000, 0x0, 0xffff0000, 0x0, 0x50, 0x51, 0x54, 0x52, 0x53, 0x8000, 0x5000, 0x205
    .long 0x0, 0x200, 0xffff0000, 0x0, 0x0, 0xffff, 0x0, 0xffff, 0x55, 0x56, 0x57, 0x58, 0x59, 0x8000, 0x5400, 0x205
    .long 0x0, 0x0, 0xffff0000, 0x0, 0xffff0000, 0x0, 0x0, 0xffff, 0x5a, 0x5b, 0x5c, 0x5d, 0x5e, 0x5f, 0x5a00, 0x206
    .long 0x0, 0x0, 0xffff0000, 0x0, 0xffff0000, 0x0, 0x0, 0xffff, 0x60, 0x61, 0x62, 0x63, 0x64, 0x65, 0x6000, 0x206
    .long 0x0, 0x0, 0xffff0000, 0x0, 0xffff0000, 0x0, 0x0, 0xffff, 0x66, 0x67, 0x68, 0x69, 0x6a, 0x6b, 0x6600, 0x206
    .long 0x0, 0x0, 0xffff0000, 0x0, 0xffff0000, 0x0, 0x0, 0xffff, 0x6c, 0x6d, 0x6e, 0x6f, 0x70, 0x8000, 0x6c00, 0x205
    .long 0x200, 0x200, 0x0, 0xffff, 0x0, 0xffff, 0xffff, 0x0, 0x72, 0x73, 0x74, 0x75, 0x71, 0x8000, 0x7000, 0x205
    .long 0x200, 0x200, 0xffff, 0x0, 0xffff, 0x0, 0x0, 0xffff, 0x78, 0x79, 0x76, 0x77, 0x7a, 0x8000, 0x7600, 0x205
    .long 0x200, 0x200, 0xffff, 0x0, 0x0, 0xffff, 0x0, 0xffff, 0x7c, 0x7d, 0x7b, 0x7e, 0x7f, 0x8000, 0x7a00, 0x205
    .long 0x0, 0x0, 0x0, 0x0, 0x0, 0x0, 0x0, 0x0, 0x8000, 0x8000, 0x8000, 0x8000, 0x8000, 0x8000, 0x0, 0x0
.section .rodata,"a"
.p2align 6
.amdhsa_kernel standalone__glu_gated_geglu__prompt_kernel
  .amdhsa_next_free_vgpr 448
  .amdhsa_next_free_sgpr 102
  .amdhsa_accum_offset 256
  .amdhsa_group_segment_fixed_size 0
  .amdhsa_kernarg_size 56
  .amdhsa_user_sgpr_count 2
  .amdhsa_user_sgpr_kernarg_segment_ptr 1
  .amdhsa_system_sgpr_workgroup_id_x 1
  .amdhsa_float_denorm_mode_32 3
.end_amdhsa_kernel
```
